```python
import torch

def _softmax(x, axis=-1):
    return torch.softmax(x, dim=axis)
def _gelu(x):
    return torch.nn.functional.gelu(x, approximate="tanh")
def _silu(x):
    return torch.nn.functional.silu(x)
def _sigmoid(x):
    return torch.sigmoid(x)
def _layernorm(x, axis=-1, eps=1e-5):
    m = x.mean(dim=axis, keepdim=True)
    v = x.var(dim=axis, keepdim=True, unbiased=False)
    return (x - m) / torch.sqrt(v + eps)
def _scatter_add(tgt, idx, src, axis=0):
    return tgt.clone().index_add_(axis, idx, src)
def _segment_sum(src, seg, n):
    out = torch.zeros((n,) + src.shape[1:], dtype=src.dtype)
    return out.index_add_(0, seg, src)
def _pad(x, pw):
    flat = tuple(v for pair in reversed(pw) for v in pair)
    return torch.nn.functional.pad(x, flat)

kernel_name = 'sequential_preLN__linear_attn_block__swiglu_ffn__prompt'

def setup_inputs():

    _w = (lambda a: (lambda t: t.to(torch.bfloat16) if t.is_floating_point() else t)(torch.as_tensor(a)))
    def _A_setup():
        B, S, D = 1, 2048, 512
        return {
            "x": _w((lambda *s: torch.randn(*s, dtype=torch.bfloat16) * 0.05)(B, S, D)),
            "wqkv": _w((lambda *s: torch.randn(*s, dtype=torch.bfloat16) * 0.05)(D, 3 * D)),
            "wo": _w((lambda *s: torch.randn(*s, dtype=torch.bfloat16) * 0.05)(D, D)),
        }
    _A_in = _A_setup()

    def _B_setup():
        B, S, D, F = 1, 2048, 512, 1376
        return {
            "x": _w((lambda *s: torch.randn(*s, dtype=torch.bfloat16) * 0.05)(B, S, D)),
            "w_gate": _w((lambda *s: torch.randn(*s, dtype=torch.bfloat16) * 0.05)(D, F)),
            "w_up": _w((lambda *s: torch.randn(*s, dtype=torch.bfloat16) * 0.05)(D, F)),
            "w_down": _w((lambda *s: torch.randn(*s, dtype=torch.bfloat16) * 0.05)(F, D)),
        }
    _B_in = _B_setup()

    return {
        "A_x": _A_in["x"],
        "A_wqkv": _A_in["wqkv"],
        "A_wo": _A_in["wo"],
        "B_x": _B_in["x"],
        "B_w_gate": _B_in["w_gate"],
        "B_w_up": _B_in["w_up"],
        "B_w_down": _B_in["w_down"],
    }

def reference(A_x, A_wqkv, A_wo, B_x, B_w_gate, B_w_up, B_w_down):
    def _A_ref(x, wqkv, wo):
        B, S, D = x.shape
        H = 32; Dh = D // H
        qkv = (lambda x, *d: x.permute(*d))((x @ wqkv).reshape(B, S, 3, H, Dh), 2, 0, 3, 1, 4)
        q, k, v = qkv[0], qkv[1], qkv[2]
        phi = lambda t: torch.where(t > 0, t + 1, torch.exp(t)) + 1e-6
        pq, pk = phi(q), phi(k)
        kv = torch.einsum("bhsd,bhse->bhde", pk, v)
        z = torch.einsum("bhsd->bhd", pk)
        num = torch.einsum("bhqd,bhde->bhqe", pq, kv)
        den = torch.einsum("bhqd,bhd->bhq", pq, z)[..., None] + 1e-6
        o = num / den
        return (lambda x, *d: x.permute(*d))(o, 0, 2, 1, 3).reshape(B, S, D) @ wo

    def _B_ref(x, w_gate, w_up, w_down):
        g = _silu(x @ w_gate)
        u = x @ w_up
        return (g * u) @ w_down

    x = A_x
    h = x + _A_ref(_layernorm(x, axis=-1), A_wqkv, A_wo)
    h2 = h + _B_ref(_layernorm(h, axis=-1), B_w_gate, B_w_up, B_w_down)
    return h2
```

```asm
; @launch grid=(256,1,1) block=(256,1,1) lds=163840
.amdgcn_target "amdgcn-amd-amdhsa--gfx950"
.text
.globl sequential_preLN__linear_attn_block__swiglu_ffn__prompt_kernel
.p2align 12
.p2align 8
.type sequential_preLN__linear_attn_block__swiglu_ffn__prompt_kernel,@function
sequential_preLN__linear_attn_block__swiglu_ffn__prompt_kernel:
    s_cmp_ge_u32 s2, 256
    s_cbranch_scc1 L_end
    s_load_dwordx2 s[8:9], s[0:1], 0
    s_load_dwordx2 s[12:13], s[0:1], 8
    s_load_dwordx16 s[16:31], s[0:1], 16
    s_lshr_b32 s41, s2, 3
    s_getpc_b64 s[62:63]
    v_lshrrev_b32 v11, 5, v0
    s_lshl_b32 s54, s41, 7
    v_lshl_add_u32 v11, v11, 12, s54
    v_lshrrev_b32 v8, 6, v0
    global_load_dword v219, v11, s[62:63]
    v_and_b32 v1, 63, v0
    v_readfirstlane_b32 s48, v8
    s_and_b32 s40, s2, 7
    s_and_b32 s3, s2, 6
    s_lshl_b32 s54, s3, 2
    s_lshr_b32 s42, s2, 5
    s_add_u32 s42, s42, s54
    s_and_b32 s54, s2, 1
    s_and_b32 s43, s41, 3
    s_lshl2_add_u32 s43, s54, s43
    s_lshl2_add_u32 s3, s54, s3
    s_and_b32 s55, s43, 1
    s_lshl1_add_u32 s3, s55, s3
    s_and_b32 s55, s42, 1
    s_add_u32 s3, s55, s3
    s_cmp_eq_u32 s43, 3
    s_cselect_b32 s3, s42, s3
    s_and_b32 s3, s3, 7
    s_lshl_b32 s3, s3, 7
    s_mov_b32 s10, 2097152
    s_mov_b32 s11, 0x20000
    s_mov_b32 s14, 1572864
    s_mov_b32 s15, 0x20000
    s_lshl_b32 s53, s48, 11
    s_lshl_b32 s60, s48, 12
    v_lshrrev_b32 v8, 3, v1
    v_and_b32 v9, 7, v1
    v_lshrrev_b32 v2, 4, v1
    v_xor_b32 v11, v2, v9
    v_lshlrev_b32 v11, 4, v11
    s_lshl2_add_u32 s56, s42, s48
    s_lshl_b32 s56, s56, 14
    v_lshl_or_b32 v4, v8, 10, v11
    v_or_b32 v4, s56, v4
    v_xor_b32 v5, 64, v4
    v_add_u32 v5, 7168, v5
    v_and_b32 v10, 1, v2
    s_and_b32 s54, s48, 1
    s_lshl_b32 s55, s54, 2
    v_lshl_or_b32 v11, v10, 1, s55
    v_xor_b32 v11, v11, v9
    v_lshlrev_b32 v11, 4, v11
    s_mul_i32 s57, s48, 24576
    s_lshl_b32 s58, s43, 7
    s_add_u32 s57, s57, s58
    v_mul_u32_u24 v6, 0xc00, v8
    v_add3_u32 v6, v6, v11, s57
    v_add_u32 v7, 97280, v6
    v_and_b32 v3, 15, v1
    v_lshrrev_b32 v11, 1, v3
    v_xor_b32 v11, v11, v2
    v_lshlrev_b32 v11, 4, v11
    v_lshl_or_b32 v11, v3, 7, v11
    v_or_b32 v12, s53, v11
    v_xor_b32 v13, 64, v12
    v_xor_b32 v14, 2048, v12
    v_xor_b32 v15, 2112, v12
    v_xor_b32 v16, 4096, v12
    v_xor_b32 v17, 4160, v12
    v_xor_b32 v18, 6144, v12
    v_xor_b32 v19, 6208, v12
    v_lshrrev_b32 v21, 3, v3
    v_lshl_or_b32 v21, v10, 1, v21
    v_xor_b32 v21, s48, v21
    v_lshlrev_b32 v21, 5, v21
    v_lshrrev_b32 v11, 2, v3
    v_lshl_or_b32 v21, v11, 7, v21
    v_lshl_or_b32 v21, v2, 12, v21
    v_and_b32 v11, 3, v1
    v_lshl_or_b32 v21, v11, 3, v21
    v_add_u32 v21, 65536, v21
    v_mov_b32 v24, 0x3f803f80
    v_mov_b32 v25, 0x3f803f80
    v_mov_b32 v26, 0x3f803f80
    v_mov_b32 v27, 0x3f803f80
    s_lshr_b32 s54, s2, 6
    s_lshl2_add_u32 s44, s40, s54
    s_and_b32 s45, s41, 7
    s_lshr_b32 s55, s40, 1
    s_lshl2_add_u32 s46, s55, s54
    s_and_b32 s55, s40, 1
    s_lshl3_add_u32 s47, s55, s45
    s_mul_i32 s47, s55, 7
    s_add_u32 s47, s47, s45
    s_add_u32 s55, s55, 14
    s_cmp_eq_u32 s45, 7
    s_cselect_b32 s47, s55, s47
    v_lshlrev_b32 v23, 4, v1
    v_lshlrev_b32 v11, 2, v10
    v_xor_b32 v11, v11, v9
    v_lshlrev_b32 v11, 4, v11
    v_lshl_or_b32 v11, v8, 10, v11
    s_lshl_b32 s54, s48, 17
    s_lshl_b32 s58, s45, 7
    s_add_u32 s54, s54, s58
    v_add_u32 v220, s54, v11
    v_lshlrev_b32 v223, 4, v9
    v_lshl_or_b32 v223, v8, 10, v223
    s_lshl3_add_u32 s54, s44, s48
    s_lshl_b32 s54, s54, 13
    s_add_u32 s54, s54, s58
    v_add_u32 v223, s54, v223
    v_cmp_eq_u32 vcc, 0, v0
    v_mov_b32 v11, 2130706432
    s_waitcnt lgkmcnt(0)
    s_add_u32 m0, s53, 0
    s_mul_i32 s4, s3, 1536
    buffer_load_dwordx4 v4, s[8:11], s3 offen  lds
    buffer_load_dwordx4 v5, s[8:11], s3 offen offset:1024  lds
    s_add_u32 m0, s60, 65536
    s_add_u32 s5, s4, 1024
    buffer_load_dwordx4 v6, s[12:15], s5 offen  lds
    buffer_load_dwordx4 v7, s[12:15], s5 offen offset:1024  lds
    buffer_load_dwordx4 v6, s[12:15], s4 offen offset:2048  lds
    buffer_load_dwordx4 v7, s[12:15], s4 offen offset:3072  lds
    s_add_u32 s5, s3, 128
    s_and_b32 s5, s5, 0x3ff
    s_add_u32 m0, s53, 8192
    s_nop 0
    buffer_load_dwordx4 v4, s[8:11], s5 offen  lds
    buffer_load_dwordx4 v5, s[8:11], s5 offen offset:1024  lds
    s_add_u32 s5, s3, 128
    s_and_b32 s5, s5, 0x3ff
    s_mul_i32 s4, s5, 1536
    s_add_u32 m0, s60, 81920
    s_add_u32 s5, s4, 1024
    buffer_load_dwordx4 v6, s[12:15], s5 offen  lds
    buffer_load_dwordx4 v7, s[12:15], s5 offen offset:1024  lds
    v_cndmask_b32 v222, v11, 0, vcc
    v_mov_b32 v22, 0xff
    s_mov_b64 s[36:37], s[30:31]
    s_mov_b64 s[32:33], s[26:27]
    s_mov_b64 s[28:29], s[24:25]
    s_mov_b64 s[24:25], s[22:23]
    s_load_dword s49, s[36:37], 0
    s_mov_b32 s38, 15073280
    s_mov_b32 s39, 0x20000
    s_mov_b32 s18, 524288
    s_mov_b32 s19, 0x20000
    s_mov_b32 s22, 1409024
    s_mov_b32 s23, 0x20000
    s_mov_b32 s30, 1409024
    s_mov_b32 s31, 0x20000
    s_mov_b32 s34, 2097152
    s_mov_b32 s35, 0x20000
    s_mov_b32 s1, s46
    s_mul_i32 s54, s47, 192
    s_lshr_b32 s55, s48, 1
    s_mul_i32 s55, s55, 44032
    s_add_u32 s54, s54, s55
    s_cmp_eq_u32 s47, 15
    s_cselect_b32 s54, 2130706432, s54
    s_movk_i32 s56, 0x1556
    s_movk_i32 s57, 2752
    s_cmp_eq_u32 s47, 14
    s_cselect_b32 s58, 0xc0, 0
    v_add_u32 v8, 0, v1
    v_mul_u32_u24 v9, s56, v8
    v_lshrrev_b32 v9, 16, v9
    v_mul_u32_u24 v10, 12, v9
    v_sub_u32 v8, v8, v10
    v_lshrrev_b32 v10, 2, v9
    v_and_b32 v10, 2, v10
    v_xor_b32 v8, v8, v10
    v_lshlrev_b32 v8, 4, v8
    v_and_b32 v10, s58, v8
    v_mad_u32_u24 v8, v9, s57, v8
    v_lshl_add_u32 v8, v10, 22, v8
    v_add_u32 v224, s54, v8
    v_add_u32 v8, 64, v1
    v_mul_u32_u24 v9, s56, v8
    v_lshrrev_b32 v9, 16, v9
    v_mul_u32_u24 v10, 12, v9
    v_sub_u32 v8, v8, v10
    v_lshrrev_b32 v10, 2, v9
    v_and_b32 v10, 2, v10
    v_xor_b32 v8, v8, v10
    v_lshlrev_b32 v8, 4, v8
    v_and_b32 v10, s58, v8
    v_mad_u32_u24 v8, v9, s57, v8
    v_lshl_add_u32 v8, v10, 22, v8
    v_add_u32 v225, s54, v8
    v_subrev_u32 v225, 1024, v225
    v_add_u32 v8, 128, v1
    v_mul_u32_u24 v9, s56, v8
    v_lshrrev_b32 v9, 16, v9
    v_mul_u32_u24 v10, 12, v9
    v_sub_u32 v8, v8, v10
    v_lshrrev_b32 v10, 2, v9
    v_and_b32 v10, 2, v10
    v_xor_b32 v8, v8, v10
    v_lshlrev_b32 v8, 4, v8
    v_and_b32 v10, s58, v8
    v_mad_u32_u24 v8, v9, s57, v8
    v_lshl_add_u32 v8, v10, 22, v8
    v_add_u32 v226, s54, v8
    v_subrev_u32 v226, 2048, v226
    s_bitcmp1_b32 s48, 0
    s_cselect_b32 s20, s24, s20
    s_cselect_b32 s21, s25, s21
    s_and_b32 s54, s48, 1
    s_mul_i32 s54, s54, 6144
    s_lshr_b32 s55, s48, 1
    s_mul_i32 s55, s55, 3072
    s_add_u32 s6, s54, s55
    s_lshl_b32 s54, s44, 16
    s_mul_i32 s55, s48, 114688
    s_sub_u32 s54, s54, s55
    v_add_u32 v229, s54, v220
    s_lshl2_add_u32 s54, s44, s48
    s_lshl_b32 s54, s54, 12
    s_lshl_b32 s55, s45, 7
    s_add_u32 s54, s54, s55
    v_lshl_add_u32 v230, v2, 10, s54
    s_lshl2_add_u32 s54, s41, s48
    s_lshl_b32 s54, s54, 12
    s_add_u32 s54, s54, 384
    v_lshl_add_u32 v8, v2, 10, s54
    s_mov_b32 vcc_lo, 0xaaaaaaaa
    s_mov_b32 vcc_hi, 0xaaaaaaaa
    v_cndmask_b32 v230, v230, v8, vcc
    s_lshl_b32 s54, s48, 8
    s_add_u32 s55, s54, 139264
    v_lshl_add_u32 v231, v1, 2, s55
    v_lshrrev_b32 v8, 2, v3
    v_lshl_add_u32 v8, v8, 4, v3
    v_lshl_add_u32 v248, v8, 2, s55
    v_mul_u32_u24 v8, 80, v2
    v_add_u32 v249, s55, v8
    s_lshl2_add_u32 s54, s43, s48
    s_lshl_b32 s55, s42, 5
    s_add_u32 s55, s54, s55
    s_lshl_b32 s55, s55, 11
    s_add_u32 s100, s55, 2162688
    s_lshl_b32 s54, s54, 5
    s_add_u32 s54, s54, s42
    s_mul_i32 s54, s54, 1152
    s_add_u32 s101, s54, 655360
    s_lshr_b32 s55, s48, 1
    s_and_b32 s56, s48, 1
    s_lshl2_add_u32 s55, s55, s56
    s_lshl_b32 s55, s55, 8
    v_xor_b32 v250, s55, v23
    v_and_b32 v8, 1, v1
    v_lshlrev_b32 v9, 6, v8
    v_lshl_or_b32 v251, v2, 4, v9
    v_and_b32 v9, 14, v1
    v_lshl_or_b32 v251, v9, 27, v251
    s_lshr_b32 s27, s44, 1
    s_lshl3_add_u32 s7, s48, s40
    s_lshl_b32 s54, s7, 7
    s_mul_i32 s55, s41, 1152
    s_add_u32 s25, s55, s54
    s_add_u32 s25, s25, 1835008
    s_lshl_b32 s55, s55, 5
    s_add_u32 s24, s55, s54
    s_add_u32 s24, s24, 655360
    s_cmp_gt_u32 s7, 8
    s_cselect_b32 s24, 2130706432, s24
    s_cselect_b32 s25, 2130706432, s25
    s_cselect_b32 s26, 0, 1
    s_bitcmp1_b32 s7, 1
    s_cselect_b32 s54, -1, 0
    s_cmp_eq_u32 s48, 0
    s_cbranch_scc1 L_pg1
    s_cmp_eq_u32 s48, 1
    s_cbranch_scc1 L_pg2
    s_cmp_eq_u32 s48, 2
    s_cbranch_scc1 L_pg3
    s_branch L_pg4
L_pgback1:
    s_add_u32 s5, s3, 128
    s_and_b32 s5, s5, 0x3ff
    s_mul_i32 s4, s5, 1536
    s_add_u32 m0, s60, 81920
    s_add_u32 s5, s4, 1024
    buffer_load_dwordx4 v6, s[12:15], s4 offen offset:2048  lds
    buffer_load_dwordx4 v7, s[12:15], s4 offen offset:3072  lds
    s_add_u32 s5, s3, 256
    s_and_b32 s5, s5, 0x3ff
    s_add_u32 m0, s53, 16384
    s_mul_i32 s4, s5, 1536
    buffer_load_dwordx4 v4, s[8:11], s5 offen  lds
    buffer_load_dwordx4 v5, s[8:11], s5 offen offset:1024  lds
    s_add_u32 m0, s60, 98304
    s_add_u32 s5, s4, 1024
    buffer_load_dwordx4 v6, s[12:15], s5 offen  lds
    buffer_load_dwordx4 v7, s[12:15], s5 offen offset:1024  lds
    buffer_load_dwordx4 v6, s[12:15], s4 offen offset:2048  lds
    buffer_load_dwordx4 v7, s[12:15], s4 offen offset:3072  lds
    s_waitcnt vmcnt(12)
    s_barrier
    ds_read_b64_tr_b16 v[28:29], v21 offset:0
    ds_read_b64_tr_b16 v[30:31], v21 offset:512
    ds_read_b64_tr_b16 v[36:37], v21 offset:2048
    ds_read_b64_tr_b16 v[38:39], v21 offset:2560
    ds_read_b128 a[0:3], v12 offset:0
    ds_read_b128 a[4:7], v14 offset:0
    ds_read_b128 a[8:11], v16 offset:0
    ds_read_b128 a[12:15], v18 offset:0
    ds_read_b64_tr_b16 v[32:33], v21 offset:1024
    ds_read_b64_tr_b16 v[34:35], v21 offset:1536
    ds_read_b64_tr_b16 v[40:41], v21 offset:3072
    ds_read_b64_tr_b16 v[42:43], v21 offset:3584
    ds_read_b128 a[16:19], v13 offset:0
    ds_read_b128 a[20:23], v15 offset:0
    ds_read_b128 a[24:27], v17 offset:0
    ds_read_b128 a[28:31], v19 offset:0
    s_add_u32 s5, s3, 384
    s_and_b32 s5, s5, 0x3ff
    s_add_u32 m0, s53, 24576
    s_mul_i32 s4, s5, 1536
    buffer_load_dwordx4 v4, s[8:11], s5 offen  lds
    buffer_load_dwordx4 v5, s[8:11], s5 offen offset:1024  lds
    s_add_u32 m0, s60, 114688
    s_add_u32 s5, s4, 1024
    buffer_load_dwordx4 v6, s[12:15], s5 offen  lds
    buffer_load_dwordx4 v7, s[12:15], s5 offen offset:1024  lds
    buffer_load_dwordx4 v6, s[12:15], s4 offen offset:2048  lds
    buffer_load_dwordx4 v7, s[12:15], s4 offen offset:3072  lds
    s_waitcnt vmcnt(12)
    s_waitcnt lgkmcnt(0)
    s_barrier
    v_mfma_f32_16x16x32_bf16 v[96:99], a[0:3], a[0:3], 0
    ds_read_b64_tr_b16 v[44:45], v21 offset:16384
    s_add_u32 s5, s3, 512
    v_mfma_f32_16x16x32_bf16 v[100:103], v[24:27], a[0:3], 0
    ds_read_b64_tr_b16 v[46:47], v21 offset:16896
    s_and_b32 s5, s5, 0x3ff
    v_mfma_f32_16x16x32_bf16 v[96:99], a[16:19], a[16:19], v[96:99]
    ds_read_b64_tr_b16 v[52:53], v21 offset:18432
    s_add_u32 m0, s53, 32768
    s_mul_i32 s4, s5, 1536
    buffer_load_dwordx4 v4, s[8:11], s5 offen  lds
    v_mfma_f32_16x16x32_bf16 v[100:103], v[24:27], a[16:19], v[100:103]
    ds_read_b64_tr_b16 v[54:55], v21 offset:18944
    s_cmp_eq_u32 s7, 8
    s_cselect_b32 s7, 0xaaaaaaaa, s54
    v_mfma_f32_16x16x32_bf16 v[136:139], v[24:27], v[28:31], 0
    ds_read_b128 a[32:35], v12 offset:8192
    v_mfma_f32_16x16x32_bf16 v[140:143], v[24:27], v[36:39], 0
    ds_read_b128 a[36:39], v14 offset:8192
    v_mfma_f32_16x16x32_bf16 v[104:107], a[0:3], v[28:31], 0
    ds_read_b128 a[40:43], v16 offset:8192
    buffer_load_dwordx4 v5, s[8:11], s5 offen offset:1024  lds
    v_mfma_f32_16x16x32_bf16 v[120:123], a[0:3], v[36:39], 0
    ds_read_b128 a[44:47], v18 offset:8192
    s_add_u32 m0, s60, 65536
    v_mfma_f32_16x16x32_bf16 v[108:111], a[4:7], v[28:31], 0
    ds_read_b64_tr_b16 v[48:49], v21 offset:17408
    s_add_u32 s5, s4, 1024
    v_mfma_f32_16x16x32_bf16 v[124:127], a[4:7], v[36:39], 0
    ds_read_b64_tr_b16 v[50:51], v21 offset:17920
    v_lshrrev_b32 v8, 3, v1
    v_mfma_f32_16x16x32_bf16 v[112:115], a[8:11], v[28:31], 0
    ds_read_b64_tr_b16 v[56:57], v21 offset:19456
    buffer_load_dwordx4 v6, s[12:15], s5 offen  lds
    v_mfma_f32_16x16x32_bf16 v[128:131], a[8:11], v[36:39], 0
    ds_read_b64_tr_b16 v[58:59], v21 offset:19968
    v_and_b32 v9, 7, v1
    v_mfma_f32_16x16x32_bf16 v[116:119], a[12:15], v[28:31], 0
    ds_read_b128 a[48:51], v13 offset:8192
    v_mfma_f32_16x16x32_bf16 v[132:135], a[12:15], v[36:39], 0
    ds_read_b128 a[52:55], v15 offset:8192
    v_lshlrev_b32 v9, 4, v9
    v_mfma_f32_16x16x32_bf16 v[136:139], v[24:27], v[32:35], v[136:139]
    ds_read_b128 a[56:59], v17 offset:8192
    buffer_load_dwordx4 v7, s[12:15], s5 offen offset:1024  lds
    v_mfma_f32_16x16x32_bf16 v[140:143], v[24:27], v[40:43], v[140:143]
    ds_read_b128 a[60:63], v19 offset:8192
    v_mul_u32_u24 v8, 4608, v8
    v_mfma_f32_16x16x32_bf16 v[104:107], a[16:19], v[32:35], v[104:107]
    v_add_u32 v253, v8, v9
    v_mfma_f32_16x16x32_bf16 v[120:123], a[16:19], v[40:43], v[120:123]
    v_lshl_add_u32 v221, v8, 3, v9
    s_lshl_b32 s54, s2, 8
    v_mfma_f32_16x16x32_bf16 v[108:111], a[20:23], v[32:35], v[108:111]
    buffer_load_dwordx4 v6, s[12:15], s4 offen offset:2048  lds
    s_add_u32 s99, s54, 4096
    v_mfma_f32_16x16x32_bf16 v[124:127], a[20:23], v[40:43], v[124:127]
    s_cmp_ge_u32 s2, 88
    s_cselect_b32 s55, 8, 0
    v_mfma_f32_16x16x32_bf16 v[112:115], a[24:27], v[32:35], v[112:115]
    s_add_u32 s99, s99, s55
    v_mfma_f32_16x16x32_bf16 v[128:131], a[24:27], v[40:43], v[128:131]
    s_cmp_ge_u32 s2, 216
    s_cselect_b32 s99, 2130706432, s99
    v_mfma_f32_16x16x32_bf16 v[116:119], a[28:31], v[32:35], v[116:119]
    buffer_load_dwordx4 v7, s[12:15], s4 offen offset:3072  lds
    v_mfma_f32_16x16x32_bf16 v[132:135], a[28:31], v[40:43], v[132:135]
    s_waitcnt vmcnt(12)
    s_waitcnt lgkmcnt(0)
    s_barrier
    v_mfma_f32_16x16x32_bf16 v[96:99], a[32:35], a[32:35], v[96:99]
    ds_read_b64_tr_b16 v[28:29], v21 offset:32768
    s_add_u32 s5, s3, 640
    v_mfma_f32_16x16x32_bf16 v[100:103], v[24:27], a[32:35], v[100:103]
    ds_read_b64_tr_b16 v[30:31], v21 offset:33280
    s_and_b32 s5, s5, 0x3ff
    v_mfma_f32_16x16x32_bf16 v[96:99], a[48:51], a[48:51], v[96:99]
    ds_read_b64_tr_b16 v[36:37], v21 offset:34816
    s_add_u32 m0, s53, 40960
    s_mul_i32 s4, s5, 1536
    buffer_load_dwordx4 v4, s[8:11], s5 offen  lds
    v_mfma_f32_16x16x32_bf16 v[100:103], v[24:27], a[48:51], v[100:103]
    ds_read_b64_tr_b16 v[38:39], v21 offset:35328
    v_lshrrev_b32 v8, 2, v3
    v_mfma_f32_16x16x32_bf16 v[136:139], v[24:27], v[44:47], v[136:139]
    ds_read_b128 a[64:67], v12 offset:16384
    v_mfma_f32_16x16x32_bf16 v[140:143], v[24:27], v[52:55], v[140:143]
    ds_read_b128 a[68:71], v14 offset:16384
    v_lshrrev_b32 v10, 1, v8
    v_mfma_f32_16x16x32_bf16 v[104:107], a[32:35], v[44:47], v[104:107]
    ds_read_b128 a[72:75], v16 offset:16384
    buffer_load_dwordx4 v5, s[8:11], s5 offen offset:1024  lds
    v_mfma_f32_16x16x32_bf16 v[120:123], a[32:35], v[52:55], v[120:123]
    ds_read_b128 a[76:79], v18 offset:16384
    s_add_u32 m0, s60, 81920
    v_mfma_f32_16x16x32_bf16 v[108:111], a[36:39], v[44:47], v[108:111]
    ds_read_b64_tr_b16 v[32:33], v21 offset:33792
    s_add_u32 s5, s4, 1024
    v_mfma_f32_16x16x32_bf16 v[124:127], a[36:39], v[52:55], v[124:127]
    ds_read_b64_tr_b16 v[34:35], v21 offset:34304
    v_lshlrev_b32 v9, 7, v8
    v_mfma_f32_16x16x32_bf16 v[112:115], a[40:43], v[44:47], v[112:115]
    ds_read_b64_tr_b16 v[40:41], v21 offset:35840
    buffer_load_dwordx4 v6, s[12:15], s5 offen  lds
    v_mfma_f32_16x16x32_bf16 v[128:131], a[40:43], v[52:55], v[128:131]
    ds_read_b64_tr_b16 v[42:43], v21 offset:36352
    v_lshl_or_b32 v9, v10, 6, v9
    v_mfma_f32_16x16x32_bf16 v[116:119], a[44:47], v[44:47], v[116:119]
    ds_read_b128 a[80:83], v13 offset:16384
    v_mfma_f32_16x16x32_bf16 v[132:135], a[44:47], v[52:55], v[132:135]
    ds_read_b128 a[84:87], v15 offset:16384
    v_and_b32 v8, 1, v2
    v_mfma_f32_16x16x32_bf16 v[136:139], v[24:27], v[48:51], v[136:139]
    ds_read_b128 a[88:91], v17 offset:16384
    buffer_load_dwordx4 v7, s[12:15], s5 offen offset:1024  lds
    v_mfma_f32_16x16x32_bf16 v[140:143], v[24:27], v[56:59], v[140:143]
    ds_read_b128 a[92:95], v19 offset:16384
    v_lshl_or_b32 v9, v8, 5, v9
    v_mfma_f32_16x16x32_bf16 v[104:107], a[48:51], v[48:51], v[104:107]
    v_and_b32 v8, 3, v1
    v_mfma_f32_16x16x32_bf16 v[120:123], a[48:51], v[56:59], v[120:123]
    v_lshl_or_b32 v9, v8, 3, v9
    v_lshrrev_b32 v8, 1, v2
    v_mfma_f32_16x16x32_bf16 v[108:111], a[52:55], v[48:51], v[108:111]
    buffer_load_dwordx4 v6, s[12:15], s4 offen offset:2048  lds
    s_add_u32 s54, s53, 32768
    v_mfma_f32_16x16x32_bf16 v[124:127], a[52:55], v[56:59], v[124:127]
    v_lshl_or_b32 v232, v8, 10, v9
    v_mfma_f32_16x16x32_bf16 v[112:115], a[56:59], v[48:51], v[112:115]
    v_add_u32 v232, s54, v232
    v_xor_b32 v233, 64, v232
    v_mfma_f32_16x16x32_bf16 v[128:131], a[56:59], v[56:59], v[128:131]
    s_add_u32 s54, s60, 0
    v_mfma_f32_16x16x32_bf16 v[116:119], a[60:63], v[48:51], v[116:119]
    buffer_load_dwordx4 v7, s[12:15], s4 offen offset:3072  lds
    v_lshl_or_b32 v236, v8, 9, v9
    v_mfma_f32_16x16x32_bf16 v[132:135], a[60:63], v[56:59], v[132:135]
    s_waitcnt vmcnt(12)
    s_waitcnt lgkmcnt(0)
    s_barrier
    v_mfma_f32_16x16x32_bf16 v[96:99], a[64:67], a[64:67], v[96:99]
    ds_read_b64_tr_b16 v[44:45], v21 offset:49152
    s_add_u32 s5, s3, 768
    v_mfma_f32_16x16x32_bf16 v[100:103], v[24:27], a[64:67], v[100:103]
    ds_read_b64_tr_b16 v[46:47], v21 offset:49664
    s_and_b32 s5, s5, 0x3ff
    v_mfma_f32_16x16x32_bf16 v[96:99], a[80:83], a[80:83], v[96:99]
    ds_read_b64_tr_b16 v[52:53], v21 offset:51200
    s_add_u32 m0, s53, 49152
    s_mul_i32 s4, s5, 1536
    buffer_load_dwordx4 v4, s[8:11], s5 offen  lds
    v_mfma_f32_16x16x32_bf16 v[100:103], v[24:27], a[80:83], v[100:103]
    ds_read_b64_tr_b16 v[54:55], v21 offset:51712
    v_mfma_f32_16x16x32_bf16 v[136:139], v[24:27], v[28:31], v[136:139]
    ds_read_b128 a[96:99], v12 offset:24576
    v_add_u32 v236, s54, v236
    v_mfma_f32_16x16x32_bf16 v[140:143], v[24:27], v[36:39], v[140:143]
    ds_read_b128 a[100:103], v14 offset:24576
    v_xor_b32 v237, 64, v236
    v_mfma_f32_16x16x32_bf16 v[104:107], a[64:67], v[28:31], v[104:107]
    ds_read_b128 a[104:107], v16 offset:24576
    buffer_load_dwordx4 v5, s[8:11], s5 offen offset:1024  lds
    v_mfma_f32_16x16x32_bf16 v[120:123], a[64:67], v[36:39], v[120:123]
    ds_read_b128 a[108:111], v18 offset:24576
    s_add_u32 m0, s60, 98304
    v_mfma_f32_16x16x32_bf16 v[108:111], a[68:71], v[28:31], v[108:111]
    ds_read_b64_tr_b16 v[48:49], v21 offset:50176
    s_add_u32 s5, s4, 1024
    v_mfma_f32_16x16x32_bf16 v[124:127], a[68:71], v[36:39], v[124:127]
    ds_read_b64_tr_b16 v[50:51], v21 offset:50688
    v_lshrrev_b32 v8, 2, v3
    v_mfma_f32_16x16x32_bf16 v[112:115], a[72:75], v[28:31], v[112:115]
    ds_read_b64_tr_b16 v[56:57], v21 offset:52224
    buffer_load_dwordx4 v6, s[12:15], s5 offen  lds
    v_mfma_f32_16x16x32_bf16 v[128:131], a[72:75], v[36:39], v[128:131]
    ds_read_b64_tr_b16 v[58:59], v21 offset:52736
    v_mfma_f32_16x16x32_bf16 v[116:119], a[76:79], v[28:31], v[116:119]
    ds_read_b128 a[112:115], v13 offset:24576
    v_lshl_add_u32 v8, v2, 3, v8
    v_mfma_f32_16x16x32_bf16 v[132:135], a[76:79], v[36:39], v[132:135]
    ds_read_b128 a[116:119], v15 offset:24576
    v_mul_u32_u24 v8, 192, v8
    v_mfma_f32_16x16x32_bf16 v[136:139], v[24:27], v[32:35], v[136:139]
    ds_read_b128 a[120:123], v17 offset:24576
    buffer_load_dwordx4 v7, s[12:15], s5 offen offset:1024  lds
    s_branch L_pgo1
L_pg1:
    s_branch L_pgback1
L_pgo1:
    v_mfma_f32_16x16x32_bf16 v[140:143], v[24:27], v[40:43], v[140:143]
    ds_read_b128 a[124:127], v19 offset:24576
    v_and_b32 v9, 1, v2
    v_mfma_f32_16x16x32_bf16 v[104:107], a[80:83], v[32:35], v[104:107]
    v_xor_b32 v10, s48, v9
    v_mfma_f32_16x16x32_bf16 v[120:123], a[80:83], v[40:43], v[120:123]
    v_lshl_add_u32 v10, v10, 5, v8
    v_and_b32 v11, 3, v1
    v_mfma_f32_16x16x32_bf16 v[108:111], a[84:87], v[32:35], v[108:111]
    buffer_load_dwordx4 v6, s[12:15], s4 offen offset:2048  lds
    v_mfma_f32_16x16x32_bf16 v[124:127], a[84:87], v[40:43], v[124:127]
    v_lshl_add_u32 v227, v11, 3, v10
    s_lshr_b32 s54, s48, 1
    v_mfma_f32_16x16x32_bf16 v[112:115], a[88:91], v[32:35], v[112:115]
    s_add_u32 s54, s54, 4
    v_mfma_f32_16x16x32_bf16 v[128:131], a[88:91], v[40:43], v[128:131]
    v_xor_b32 v10, s54, v9
    v_lshl_add_u32 v10, v10, 5, v8
    v_mfma_f32_16x16x32_bf16 v[116:119], a[92:95], v[32:35], v[116:119]
    buffer_load_dwordx4 v7, s[12:15], s4 offen offset:3072  lds
    s_and_b32 s54, s48, 1
    v_mfma_f32_16x16x32_bf16 v[132:135], a[92:95], v[40:43], v[132:135]
    s_waitcnt vmcnt(12)
    s_waitcnt lgkmcnt(0)
    s_barrier
    v_mfma_f32_16x16x32_bf16 v[96:99], a[96:99], a[96:99], v[96:99]
    ds_read_b64_tr_b16 v[28:29], v21 offset:0
    s_add_u32 s5, s3, 896
    v_mfma_f32_16x16x32_bf16 v[100:103], v[24:27], a[96:99], v[100:103]
    ds_read_b64_tr_b16 v[30:31], v21 offset:512
    s_and_b32 s5, s5, 0x3ff
    v_mfma_f32_16x16x32_bf16 v[96:99], a[112:115], a[112:115], v[96:99]
    ds_read_b64_tr_b16 v[36:37], v21 offset:2048
    s_add_u32 m0, s53, 57344
    s_mul_i32 s4, s5, 1536
    buffer_load_dwordx4 v4, s[8:11], s5 offen  lds
    v_mfma_f32_16x16x32_bf16 v[100:103], v[24:27], a[112:115], v[100:103]
    ds_read_b64_tr_b16 v[38:39], v21 offset:2560
    v_mfma_f32_16x16x32_bf16 v[136:139], v[24:27], v[44:47], v[136:139]
    ds_read_b128 a[128:131], v12 offset:32768
    s_lshl_b32 s54, s54, 4
    v_mfma_f32_16x16x32_bf16 v[140:143], v[24:27], v[52:55], v[140:143]
    ds_read_b128 a[132:135], v14 offset:32768
    v_add_u32 v10, s54, v10
    v_mfma_f32_16x16x32_bf16 v[104:107], a[96:99], v[44:47], v[104:107]
    ds_read_b128 a[136:139], v16 offset:32768
    buffer_load_dwordx4 v5, s[8:11], s5 offen offset:1024  lds
    v_mfma_f32_16x16x32_bf16 v[120:123], a[96:99], v[52:55], v[120:123]
    ds_read_b128 a[140:143], v18 offset:32768
    s_add_u32 m0, s60, 114688
    v_mfma_f32_16x16x32_bf16 v[108:111], a[100:103], v[44:47], v[108:111]
    ds_read_b64_tr_b16 v[32:33], v21 offset:1024
    s_add_u32 s5, s4, 1024
    v_mfma_f32_16x16x32_bf16 v[124:127], a[100:103], v[52:55], v[124:127]
    ds_read_b64_tr_b16 v[34:35], v21 offset:1536
    v_lshrrev_b32 v9, 1, v11
    v_mfma_f32_16x16x32_bf16 v[112:115], a[104:107], v[44:47], v[112:115]
    ds_read_b64_tr_b16 v[40:41], v21 offset:3072
    buffer_load_dwordx4 v6, s[12:15], s5 offen  lds
    v_mfma_f32_16x16x32_bf16 v[128:131], a[104:107], v[52:55], v[128:131]
    ds_read_b64_tr_b16 v[42:43], v21 offset:3584
    v_mfma_f32_16x16x32_bf16 v[116:119], a[108:111], v[44:47], v[116:119]
    ds_read_b128 a[144:147], v13 offset:32768
    v_lshl_add_u32 v10, v9, 3, v10
    v_mfma_f32_16x16x32_bf16 v[132:135], a[108:111], v[52:55], v[132:135]
    ds_read_b128 a[148:151], v15 offset:32768
    v_and_b32 v11, 1, v11
    v_mfma_f32_16x16x32_bf16 v[136:139], v[24:27], v[48:51], v[136:139]
    ds_read_b128 a[152:155], v17 offset:32768
    buffer_load_dwordx4 v7, s[12:15], s5 offen offset:1024  lds
    v_mfma_f32_16x16x32_bf16 v[140:143], v[24:27], v[56:59], v[140:143]
    ds_read_b128 a[156:159], v19 offset:32768
    v_mul_u32_u24 v11, 0x1800, v11
    v_mfma_f32_16x16x32_bf16 v[104:107], a[112:115], v[48:51], v[104:107]
    v_add_u32 v228, v11, v10
    v_mfma_f32_16x16x32_bf16 v[120:123], a[112:115], v[56:59], v[120:123]
    v_add_u32 v227, 40960, v227
    v_add_u32 v228, 40960, v228
    v_mfma_f32_16x16x32_bf16 v[108:111], a[116:119], v[48:51], v[108:111]
    buffer_load_dwordx4 v6, s[12:15], s4 offen offset:2048  lds
    v_mfma_f32_16x16x32_bf16 v[124:127], a[116:119], v[56:59], v[124:127]
    v_add_u32 v254, 61440, v227
    v_add_u32 v255, 61440, v228
    v_mfma_f32_16x16x32_bf16 v[112:115], a[120:123], v[48:51], v[112:115]
    v_and_b32 v8, 31, v1
    v_mfma_f32_16x16x32_bf16 v[128:131], a[120:123], v[56:59], v[128:131]
    v_lshrrev_b32 v9, 5, v1
    v_and_b32 v10, 7, v1
    v_mfma_f32_16x16x32_bf16 v[116:119], a[124:127], v[48:51], v[116:119]
    buffer_load_dwordx4 v7, s[12:15], s4 offen offset:3072  lds
    v_xor_b32 v9, v9, v10
    v_mfma_f32_16x16x32_bf16 v[132:135], a[124:127], v[56:59], v[132:135]
    s_waitcnt vmcnt(12)
    s_waitcnt lgkmcnt(0)
    s_barrier
    v_mfma_f32_16x16x32_bf16 v[96:99], a[128:131], a[128:131], v[96:99]
    ds_read_b64_tr_b16 v[44:45], v21 offset:16384
    s_add_u32 m0, s60, 65536
    v_mfma_f32_16x16x32_bf16 v[100:103], v[24:27], a[128:131], v[100:103]
    ds_read_b64_tr_b16 v[46:47], v21 offset:16896
    s_mul_i32 s4, s3, 1536
    v_mfma_f32_16x16x32_bf16 v[96:99], a[144:147], a[144:147], v[96:99]
    ds_read_b64_tr_b16 v[52:53], v21 offset:18432
    v_mfma_f32_16x16x32_bf16 v[100:103], v[24:27], a[144:147], v[100:103]
    ds_read_b64_tr_b16 v[54:55], v21 offset:18944
    buffer_load_dwordx4 v6, s[12:15], s4 offen  lds
    v_mfma_f32_16x16x32_bf16 v[136:139], v[24:27], v[28:31], v[136:139]
    ds_read_b128 a[160:163], v12 offset:40960
    v_lshlrev_b32 v9, 4, v9
    v_mfma_f32_16x16x32_bf16 v[140:143], v[24:27], v[36:39], v[140:143]
    ds_read_b128 a[164:167], v14 offset:40960
    v_lshl_or_b32 v9, v8, 8, v9
    v_mfma_f32_16x16x32_bf16 v[104:107], a[128:131], v[28:31], v[104:107]
    ds_read_b128 a[168:171], v16 offset:40960
    v_mfma_f32_16x16x32_bf16 v[120:123], a[128:131], v[36:39], v[120:123]
    ds_read_b128 a[172:175], v18 offset:40960
    s_lshl_b32 s54, s48, 13
    v_mfma_f32_16x16x32_bf16 v[108:111], a[132:135], v[28:31], v[108:111]
    ds_read_b64_tr_b16 v[48:49], v21 offset:17408
    s_add_u32 s54, s54, 0
    v_mfma_f32_16x16x32_bf16 v[124:127], a[132:135], v[36:39], v[124:127]
    ds_read_b64_tr_b16 v[50:51], v21 offset:17920
    buffer_load_dwordx4 v7, s[12:15], s4 offen offset:1024  lds
    v_mfma_f32_16x16x32_bf16 v[112:115], a[136:139], v[28:31], v[112:115]
    ds_read_b64_tr_b16 v[56:57], v21 offset:19456
    s_add_u32 s5, s3, 128
    v_mfma_f32_16x16x32_bf16 v[128:131], a[136:139], v[36:39], v[128:131]
    ds_read_b64_tr_b16 v[58:59], v21 offset:19968
    s_and_b32 s5, s5, 0x3ff
    v_mfma_f32_16x16x32_bf16 v[116:119], a[140:143], v[28:31], v[116:119]
    ds_read_b128 a[176:179], v13 offset:40960
    s_add_u32 m0, s60, 67584
    v_mfma_f32_16x16x32_bf16 v[132:135], a[140:143], v[36:39], v[132:135]
    ds_read_b128 a[180:183], v15 offset:40960
    s_mul_i32 s4, s5, 1536
    v_mfma_f32_16x16x32_bf16 v[136:139], v[24:27], v[32:35], v[136:139]
    ds_read_b128 a[184:187], v17 offset:40960
    v_add_u32 v234, s54, v9
    v_mfma_f32_16x16x32_bf16 v[140:143], v[24:27], v[40:43], v[140:143]
    ds_read_b128 a[188:191], v19 offset:40960
    buffer_load_dwordx4 v6, s[12:15], s4 offen  lds
    v_mfma_f32_16x16x32_bf16 v[104:107], a[144:147], v[32:35], v[104:107]
    v_lshrrev_b32 v8, 3, v1
    v_mfma_f32_16x16x32_bf16 v[120:123], a[144:147], v[40:43], v[120:123]
    v_lshlrev_b32 v10, 1, v10
    v_xor_b32 v10, v10, v8
    v_mfma_f32_16x16x32_bf16 v[108:111], a[148:151], v[32:35], v[108:111]
    v_lshlrev_b32 v10, 4, v10
    v_mfma_f32_16x16x32_bf16 v[124:127], a[148:151], v[40:43], v[124:127]
    v_lshl_or_b32 v10, v8, 8, v10
    s_add_u32 s54, s53, 0
    v_mfma_f32_16x16x32_bf16 v[112:115], a[152:155], v[32:35], v[112:115]
    v_add_u32 v235, s54, v10
    v_mfma_f32_16x16x32_bf16 v[128:131], a[152:155], v[40:43], v[128:131]
    buffer_load_dwordx4 v7, s[12:15], s4 offen offset:1024  lds
    s_lshr_b32 s55, s48, 1
    v_mfma_f32_16x16x32_bf16 v[116:119], a[156:159], v[32:35], v[116:119]
    s_lshl1_add_u32 s55, s44, s55
    v_mfma_f32_16x16x32_bf16 v[132:135], a[156:159], v[40:43], v[132:135]
    s_waitcnt vmcnt(10)
    s_waitcnt lgkmcnt(0)
    s_barrier
    v_mfma_f32_16x16x32_bf16 v[96:99], a[160:163], a[160:163], v[96:99]
    ds_read_b64_tr_b16 v[28:29], v21 offset:32768
    s_add_u32 s5, s3, 256
    v_mfma_f32_16x16x32_bf16 v[100:103], v[24:27], a[160:163], v[100:103]
    ds_read_b64_tr_b16 v[30:31], v21 offset:33280
    s_and_b32 s5, s5, 0x3ff
    v_mfma_f32_16x16x32_bf16 v[96:99], a[176:179], a[176:179], v[96:99]
    ds_read_b64_tr_b16 v[36:37], v21 offset:34816
    s_add_u32 m0, s60, 81920
    v_mfma_f32_16x16x32_bf16 v[100:103], v[24:27], a[176:179], v[100:103]
    ds_read_b64_tr_b16 v[38:39], v21 offset:35328
    s_mul_i32 s4, s5, 1536
    buffer_load_dwordx4 v6, s[12:15], s4 offen  lds
    v_mfma_f32_16x16x32_bf16 v[136:139], v[24:27], v[44:47], v[136:139]
    ds_read_b128 a[192:195], v12 offset:49152
    s_and_b32 s54, s55, 3
    v_mfma_f32_16x16x32_bf16 v[140:143], v[24:27], v[52:55], v[140:143]
    ds_read_b128 a[196:199], v14 offset:49152
    s_lshl2_add_u32 s54, s45, s54
    v_mfma_f32_16x16x32_bf16 v[104:107], a[160:163], v[44:47], v[104:107]
    ds_read_b128 a[200:203], v16 offset:49152
    s_mul_i32 s54, s54, 11
    v_mfma_f32_16x16x32_bf16 v[120:123], a[160:163], v[52:55], v[120:123]
    ds_read_b128 a[204:207], v18 offset:49152
    v_mfma_f32_16x16x32_bf16 v[108:111], a[164:167], v[44:47], v[108:111]
    ds_read_b64_tr_b16 v[32:33], v21 offset:33792
    s_lshr_b32 s55, s55, 2
    v_mfma_f32_16x16x32_bf16 v[124:127], a[164:167], v[52:55], v[124:127]
    ds_read_b64_tr_b16 v[34:35], v21 offset:34304
    buffer_load_dwordx4 v7, s[12:15], s4 offen offset:1024  lds
    v_mfma_f32_16x16x32_bf16 v[112:115], a[168:171], v[44:47], v[112:115]
    ds_read_b64_tr_b16 v[40:41], v21 offset:35840
    s_add_u32 s5, s3, 384
    v_mfma_f32_16x16x32_bf16 v[128:131], a[168:171], v[52:55], v[128:131]
    ds_read_b64_tr_b16 v[42:43], v21 offset:36352
    s_and_b32 s5, s5, 0x3ff
    v_mfma_f32_16x16x32_bf16 v[116:119], a[172:175], v[44:47], v[116:119]
    ds_read_b128 a[208:211], v13 offset:49152
    s_add_u32 m0, s60, 83968
    v_mfma_f32_16x16x32_bf16 v[132:135], a[172:175], v[52:55], v[132:135]
    ds_read_b128 a[212:215], v15 offset:49152
    s_mul_i32 s4, s5, 1536
    v_mfma_f32_16x16x32_bf16 v[136:139], v[24:27], v[48:51], v[136:139]
    ds_read_b128 a[216:219], v17 offset:49152
    s_add_u32 s54, s54, s55
    v_mfma_f32_16x16x32_bf16 v[140:143], v[24:27], v[56:59], v[140:143]
    ds_read_b128 a[220:223], v19 offset:49152
    buffer_load_dwordx4 v6, s[12:15], s4 offen  lds
    v_mfma_f32_16x16x32_bf16 v[104:107], a[176:179], v[48:51], v[104:107]
    s_lshl_b32 s54, s54, 12
    v_mfma_f32_16x16x32_bf16 v[120:123], a[176:179], v[56:59], v[120:123]
    s_add_u32 s98, s54, 4259840
    s_and_b32 s54, s48, 1
    v_mfma_f32_16x16x32_bf16 v[108:111], a[180:183], v[48:51], v[108:111]
    s_lshl_b32 s54, s54, 9
    v_mfma_f32_16x16x32_bf16 v[124:127], a[180:183], v[56:59], v[124:127]
    v_lshrrev_b32 v8, 5, v1
    v_lshl_or_b32 v8, v8, 8, s54
    v_mfma_f32_16x16x32_bf16 v[112:115], a[184:187], v[48:51], v[112:115]
    v_lshl_or_b32 v20, v3, 4, v8
    v_mfma_f32_16x16x32_bf16 v[128:131], a[184:187], v[56:59], v[128:131]
    buffer_load_dwordx4 v7, s[12:15], s4 offen offset:1024  lds
    v_and_b32 v10, 1, v2
    v_mfma_f32_16x16x32_bf16 v[116:119], a[188:191], v[48:51], v[116:119]
    v_lshl_add_u32 v252, v10, 10, v20
    s_cmp_ge_u32 s44, 22
    s_cselect_b32 s98, 2130706432, s98
    v_mfma_f32_16x16x32_bf16 v[132:135], a[188:191], v[56:59], v[132:135]
    s_waitcnt vmcnt(8)
    s_waitcnt lgkmcnt(0)
    s_barrier
    v_mfma_f32_16x16x32_bf16 v[96:99], a[192:195], a[192:195], v[96:99]
    ds_read_b64_tr_b16 v[44:45], v21 offset:49152
    s_add_u32 s5, s3, 512
    v_mfma_f32_16x16x32_bf16 v[100:103], v[24:27], a[192:195], v[100:103]
    ds_read_b64_tr_b16 v[46:47], v21 offset:49664
    s_and_b32 s5, s5, 0x3ff
    v_mfma_f32_16x16x32_bf16 v[96:99], a[208:211], a[208:211], v[96:99]
    ds_read_b64_tr_b16 v[52:53], v21 offset:51200
    s_add_u32 m0, s60, 98304
    v_mfma_f32_16x16x32_bf16 v[100:103], v[24:27], a[208:211], v[100:103]
    ds_read_b64_tr_b16 v[54:55], v21 offset:51712
    s_mul_i32 s4, s5, 1536
    buffer_load_dwordx4 v6, s[12:15], s4 offen  lds
    v_mfma_f32_16x16x32_bf16 v[136:139], v[24:27], v[28:31], v[136:139]
    ds_read_b128 a[224:227], v12 offset:57344
    v_mfma_f32_16x16x32_bf16 v[140:143], v[24:27], v[36:39], v[140:143]
    ds_read_b128 a[228:231], v14 offset:57344
    v_mfma_f32_16x16x32_bf16 v[104:107], a[192:195], v[28:31], v[104:107]
    ds_read_b128 a[232:235], v16 offset:57344
    v_mfma_f32_16x16x32_bf16 v[120:123], a[192:195], v[36:39], v[120:123]
    ds_read_b128 a[236:239], v18 offset:57344
    v_mfma_f32_16x16x32_bf16 v[108:111], a[196:199], v[28:31], v[108:111]
    ds_read_b64_tr_b16 v[48:49], v21 offset:50176
    v_mfma_f32_16x16x32_bf16 v[124:127], a[196:199], v[36:39], v[124:127]
    ds_read_b64_tr_b16 v[50:51], v21 offset:50688
    buffer_load_dwordx4 v7, s[12:15], s4 offen offset:1024  lds
    v_mfma_f32_16x16x32_bf16 v[112:115], a[200:203], v[28:31], v[112:115]
    ds_read_b64_tr_b16 v[56:57], v21 offset:52224
    s_add_u32 s5, s3, 640
    v_mfma_f32_16x16x32_bf16 v[128:131], a[200:203], v[36:39], v[128:131]
    ds_read_b64_tr_b16 v[58:59], v21 offset:52736
    s_and_b32 s5, s5, 0x3ff
    v_mfma_f32_16x16x32_bf16 v[116:119], a[204:207], v[28:31], v[116:119]
    ds_read_b128 a[240:243], v13 offset:57344
    s_add_u32 m0, s60, 100352
    v_mfma_f32_16x16x32_bf16 v[132:135], a[204:207], v[36:39], v[132:135]
    ds_read_b128 a[244:247], v15 offset:57344
    s_mul_i32 s4, s5, 1536
    v_mfma_f32_16x16x32_bf16 v[136:139], v[24:27], v[32:35], v[136:139]
    ds_read_b128 a[248:251], v17 offset:57344
    v_mfma_f32_16x16x32_bf16 v[140:143], v[24:27], v[40:43], v[140:143]
    ds_read_b128 a[252:255], v19 offset:57344
    buffer_load_dwordx4 v6, s[12:15], s4 offen  lds
    v_mfma_f32_16x16x32_bf16 v[104:107], a[208:211], v[32:35], v[104:107]
    s_add_u32 s49, s49, 0x01030507
    v_mfma_f32_16x16x32_bf16 v[120:123], a[208:211], v[40:43], v[120:123]
    v_mfma_f32_16x16x32_bf16 v[108:111], a[212:215], v[32:35], v[108:111]
    s_lshr_b32 s50, s49, 8
    v_mfma_f32_16x16x32_bf16 v[124:127], a[212:215], v[40:43], v[124:127]
    v_mfma_f32_16x16x32_bf16 v[112:115], a[216:219], v[32:35], v[112:115]
    s_lshr_b32 s51, s49, 16
    v_mfma_f32_16x16x32_bf16 v[128:131], a[216:219], v[40:43], v[128:131]
    buffer_load_dwordx4 v7, s[12:15], s4 offen offset:1024  lds
    v_mfma_f32_16x16x32_bf16 v[116:119], a[220:223], v[32:35], v[116:119]
    s_lshr_b32 s52, s49, 24
    v_mfma_f32_16x16x32_bf16 v[132:135], a[220:223], v[40:43], v[132:135]
    s_waitcnt lgkmcnt(0)
    s_barrier
    v_mfma_f32_16x16x32_bf16 v[96:99], a[224:227], a[224:227], v[96:99]
    s_add_u32 s5, s3, 768
    s_and_b32 s5, s5, 0x3ff
    v_mfma_f32_16x16x32_bf16 v[100:103], v[24:27], a[224:227], v[100:103]
    s_add_u32 m0, s60, 114688
    s_mul_i32 s4, s5, 1536
    v_mfma_f32_16x16x32_bf16 v[96:99], a[240:243], a[240:243], v[96:99]
    v_mfma_f32_16x16x32_bf16 v[100:103], v[24:27], a[240:243], v[100:103]
    buffer_load_dwordx4 v6, s[12:15], s4 offen  lds
    v_mfma_f32_16x16x32_bf16 v[136:139], v[24:27], v[44:47], v[136:139]
    v_mfma_f32_16x16x32_bf16 v[140:143], v[24:27], v[52:55], v[140:143]
    s_mov_b32 vcc_lo, 0x22222222
    s_mov_b32 vcc_hi, 0x22222222
    v_mfma_f32_16x16x32_bf16 v[104:107], a[224:227], v[44:47], v[104:107]
    s_nop 1
    v_mul_f32 v8, 0x3b000000, v100
    v_cndmask_b32 v9, v96, v97, vcc
    s_lshl_b64 vcc, vcc, 1
    v_mfma_f32_16x16x32_bf16 v[120:123], a[224:227], v[52:55], v[120:123]
    v_cndmask_b32 v9, v9, v98, vcc
    s_lshl_b64 vcc, vcc, 1
    v_mfma_f32_16x16x32_bf16 v[108:111], a[228:231], v[44:47], v[108:111]
    v_mul_f32 v11, v8, v8
    v_cndmask_b32 v9, v9, v99, vcc
    v_mfma_f32_16x16x32_bf16 v[124:127], a[228:231], v[52:55], v[124:127]
    buffer_load_dwordx4 v7, s[12:15], s4 offen offset:1024  lds
    s_add_u32 s5, s3, 896
    v_mfma_f32_16x16x32_bf16 v[112:115], a[232:235], v[44:47], v[112:115]
    s_and_b32 s5, s5, 0x3ff
    s_add_u32 m0, s60, 116736
    v_mul_f32 v9, 0x3b000000, v9
    v_mfma_f32_16x16x32_bf16 v[128:131], a[232:235], v[52:55], v[128:131]
    s_mul_i32 s4, s5, 1536
    v_sub_f32 v9, v9, v11
    v_mfma_f32_16x16x32_bf16 v[116:119], a[236:239], v[44:47], v[116:119]
    v_max_f32 v9, 0, v9
    v_add_f32 v9, 0x3727c5ac, v9
    v_mfma_f32_16x16x32_bf16 v[132:135], a[236:239], v[52:55], v[132:135]
    v_rsq_f32 v9, v9
    v_mfma_f32_16x16x32_bf16 v[136:139], v[24:27], v[48:51], v[136:139]
    s_mov_b32 s56, 0x3fb8aa3b
    s_mov_b32 s57, 0x3fb8aa3b
    ds_write2st64_b32 v231, v8, v9 offset0:0 offset1:4
    v_mfma_f32_16x16x32_bf16 v[140:143], v[24:27], v[56:59], v[140:143]
    buffer_load_dwordx4 v6, s[12:15], s4 offen  lds
    v_xor_b32 v9, 256, v249
    v_mfma_f32_16x16x32_bf16 v[104:107], a[240:243], v[48:51], v[104:107]
    v_xor_b32 v10, 512, v249
    v_xor_b32 v11, 768, v249
    v_mfma_f32_16x16x32_bf16 v[120:123], a[240:243], v[56:59], v[120:123]
    v_mfma_f32_16x16x32_bf16 v[108:111], a[244:247], v[48:51], v[108:111]
    v_mfma_f32_16x16x32_bf16 v[124:127], a[244:247], v[56:59], v[124:127]
    s_waitcnt vmcnt(11)
    s_waitcnt lgkmcnt(0)
    s_barrier
    v_mfma_f32_16x16x32_bf16 v[112:115], a[248:251], v[48:51], v[112:115]
    ds_read_b128 v[176:179], v249
    ds_read_b128 v[180:183], v9
    v_mfma_f32_16x16x32_bf16 v[128:131], a[248:251], v[56:59], v[128:131]
    buffer_load_dwordx4 v7, s[12:15], s4 offen offset:1024  lds
    ds_read_b128 v[184:187], v10
    ds_read_b128 v[188:191], v11
    v_mfma_f32_16x16x32_bf16 v[116:119], a[252:255], v[48:51], v[116:119]
    ds_read_b128 v[160:163], v249 offset:1024
    ds_read_b128 v[164:167], v9 offset:1024
    v_mfma_f32_16x16x32_bf16 v[132:135], a[252:255], v[56:59], v[132:135]
    ds_read_b128 v[168:171], v10 offset:1024
    ds_read_b128 v[172:175], v11 offset:1024
    ds_read_b64_tr_b16 v[28:29], v21 offset:0
    ds_read_b64_tr_b16 v[30:31], v21 offset:512
    ds_read_b64_tr_b16 v[32:33], v21 offset:1024
    ds_read_b64_tr_b16 v[34:35], v21 offset:1536
    ds_read_b64_tr_b16 v[36:37], v21 offset:2048
    ds_read_b64_tr_b16 v[38:39], v21 offset:2560
    ds_read_b64_tr_b16 v[40:41], v21 offset:3072
    buffer_load_dword v219, v230, s[16:19], 0 offen
    ds_read_b64_tr_b16 v[42:43], v21 offset:3584
    s_waitcnt lgkmcnt(15)
    v_pk_fma_f32 v[104:105], v[176:177], v[136:137], v[104:105] neg_lo:[1,0,0] neg_hi:[1,0,0]
    v_pk_fma_f32 v[106:107], v[178:179], v[136:137], v[106:107] neg_lo:[1,0,0] neg_hi:[1,0,0]
    s_waitcnt lgkmcnt(14)
    v_pk_fma_f32 v[108:109], v[180:181], v[136:137], v[108:109] neg_lo:[1,0,0] neg_hi:[1,0,0]
    v_pk_fma_f32 v[110:111], v[182:183], v[136:137], v[110:111] neg_lo:[1,0,0] neg_hi:[1,0,0]
    s_waitcnt lgkmcnt(13)
    v_pk_fma_f32 v[112:113], v[184:185], v[136:137], v[112:113] neg_lo:[1,0,0] neg_hi:[1,0,0]
    v_pk_fma_f32 v[114:115], v[186:187], v[136:137], v[114:115] neg_lo:[1,0,0] neg_hi:[1,0,0]
    s_waitcnt lgkmcnt(12)
    v_pk_fma_f32 v[116:117], v[188:189], v[136:137], v[116:117] neg_lo:[1,0,0] neg_hi:[1,0,0]
    v_pk_fma_f32 v[118:119], v[190:191], v[136:137], v[118:119] neg_lo:[1,0,0] neg_hi:[1,0,0]
    v_pk_fma_f32 v[120:121], v[176:177], v[140:141], v[120:121] neg_lo:[1,0,0] neg_hi:[1,0,0]
    v_pk_fma_f32 v[122:123], v[178:179], v[140:141], v[122:123] neg_lo:[1,0,0] neg_hi:[1,0,0]
    v_pk_fma_f32 v[124:125], v[180:181], v[140:141], v[124:125] neg_lo:[1,0,0] neg_hi:[1,0,0]
    v_pk_fma_f32 v[126:127], v[182:183], v[140:141], v[126:127] neg_lo:[1,0,0] neg_hi:[1,0,0]
    v_pk_fma_f32 v[128:129], v[184:185], v[140:141], v[128:129] neg_lo:[1,0,0] neg_hi:[1,0,0]
    v_pk_fma_f32 v[130:131], v[186:187], v[140:141], v[130:131] neg_lo:[1,0,0] neg_hi:[1,0,0]
    v_pk_fma_f32 v[132:133], v[188:189], v[140:141], v[132:133] neg_lo:[1,0,0] neg_hi:[1,0,0]
    v_pk_fma_f32 v[134:135], v[190:191], v[140:141], v[134:135] neg_lo:[1,0,0] neg_hi:[1,0,0]
    s_waitcnt lgkmcnt(11)
    v_pk_mul_f32 v[104:105], v[104:105], v[160:161]
    v_pk_mul_f32 v[106:107], v[106:107], v[162:163]
    s_waitcnt lgkmcnt(10)
    v_pk_mul_f32 v[108:109], v[108:109], v[164:165]
    v_pk_mul_f32 v[110:111], v[110:111], v[166:167]
    s_waitcnt lgkmcnt(9)
    v_pk_mul_f32 v[112:113], v[112:113], v[168:169]
    v_pk_mul_f32 v[114:115], v[114:115], v[170:171]
    s_add_u32 s96, s1, 0
    s_and_b32 s96, s96, 15
    s_add_u32 m0, s6, 151552
    s_mul_i32 s96, s96, 88064
    buffer_load_dwordx4 v224, s[20:23], s96 offen  lds
    s_waitcnt lgkmcnt(8)
    v_pk_mul_f32 v[116:117], v[116:117], v[172:173]
    v_pk_mul_f32 v[118:119], v[118:119], v[174:175]
    v_pk_mul_f32 v[120:121], v[120:121], v[160:161]
    v_pk_mul_f32 v[122:123], v[122:123], v[162:163]
    v_pk_mul_f32 v[124:125], v[124:125], v[164:165]
    v_pk_mul_f32 v[126:127], v[126:127], v[166:167]
    v_pk_mul_f32 v[128:129], v[128:129], v[168:169]
    v_pk_mul_f32 v[130:131], v[130:131], v[170:171]
    v_pk_mul_f32 v[132:133], v[132:133], v[172:173]
    v_pk_mul_f32 v[134:135], v[134:135], v[174:175]
    v_cvt_pk_bf16_f32 v68, v120, v121
    v_cvt_pk_bf16_f32 v69, v122, v123
    v_cvt_pk_bf16_f32 v70, v124, v125
    v_cvt_pk_bf16_f32 v71, v126, v127
    v_cvt_pk_bf16_f32 v72, v128, v129
    v_cvt_pk_bf16_f32 v73, v130, v131
    v_cvt_pk_bf16_f32 v74, v132, v133
    v_cvt_pk_bf16_f32 v75, v134, v135
    v_pk_mul_f32 v[192:193], v[104:105], s[56:57]
    v_pk_mul_f32 v[194:195], v[106:107], s[56:57]
    v_pk_mul_f32 v[196:197], v[108:109], s[56:57]
    v_pk_mul_f32 v[198:199], v[110:111], s[56:57]
    buffer_load_dwordx4 v225, s[20:23], s96 offen offset:1024  lds
    v_pk_mul_f32 v[200:201], v[112:113], s[56:57]
    v_pk_mul_f32 v[202:203], v[114:115], s[56:57]
    v_pk_mul_f32 v[204:205], v[116:117], s[56:57]
    v_pk_mul_f32 v[206:207], v[118:119], s[56:57]
    v_exp_f32 v192, v192 clamp
    v_max_f32 v104, 0x358637bd, v104
    v_exp_f32 v193, v193 clamp
    v_max_f32 v105, 0x358637bd, v105
    v_exp_f32 v194, v194 clamp
    v_max_f32 v106, 0x358637bd, v106
    v_exp_f32 v195, v195 clamp
    v_max_f32 v107, 0x358637bd, v107
    v_exp_f32 v196, v196 clamp
    v_max_f32 v108, 0x358637bd, v108
    v_exp_f32 v197, v197 clamp
    v_max_f32 v109, 0x358637bd, v109
    buffer_load_dwordx4 v226, s[20:23], s96 offen offset:2048  lds
    v_exp_f32 v198, v198 clamp
    v_max_f32 v110, 0x358637bd, v110
    v_exp_f32 v199, v199 clamp
    v_max_f32 v111, 0x358637bd, v111
    v_exp_f32 v200, v200 clamp
    v_max_f32 v112, 0x358637bd, v112
    v_exp_f32 v201, v201 clamp
    v_max_f32 v113, 0x358637bd, v113
    v_exp_f32 v202, v202 clamp
    v_max_f32 v114, 0x358637bd, v114
    v_exp_f32 v203, v203 clamp
    v_max_f32 v115, 0x358637bd, v115
    v_exp_f32 v204, v204 clamp
    v_max_f32 v116, 0x358637bd, v116
    v_exp_f32 v205, v205 clamp
    v_mov_b32 v238, s49
    buffer_store_dword v238, v222, s[36:39], s99 offen sc1
    v_max_f32 v117, 0x358637bd, v117
    v_exp_f32 v206, v206 clamp
    v_max_f32 v118, 0x358637bd, v118
    v_exp_f32 v207, v207 clamp
    v_max_f32 v119, 0x358637bd, v119
    v_pk_add_f32 v[104:105], v[104:105], v[192:193]
    v_pk_add_f32 v[106:107], v[106:107], v[194:195]
    v_pk_add_f32 v[108:109], v[108:109], v[196:197]
    v_pk_add_f32 v[110:111], v[110:111], v[198:199]
    v_pk_add_f32 v[112:113], v[112:113], v[200:201]
    v_pk_add_f32 v[114:115], v[114:115], v[202:203]
    v_pk_add_f32 v[116:117], v[116:117], v[204:205]
    v_pk_add_f32 v[118:119], v[118:119], v[206:207]
    v_cvt_pk_bf16_f32 v60, v104, v105
    v_cvt_pk_bf16_f32 v61, v106, v107
    v_cvt_pk_bf16_f32 v62, v108, v109
    v_cvt_pk_bf16_f32 v63, v110, v111
    v_cvt_pk_bf16_f32 v64, v112, v113
    v_cvt_pk_bf16_f32 v65, v114, v115
    v_cvt_pk_bf16_f32 v66, v116, v117
    v_cvt_pk_bf16_f32 v67, v118, v119
    v_mfma_f32_16x16x32_bf16 v[96:99], v[60:63], v[68:71], 0
    s_nop 0
    v_mfma_f32_16x16x32_bf16 v[96:99], v[64:67], v[72:75], v[96:99]
    v_mfma_f32_16x16x32_bf16 v[100:103], v[60:63], v[24:27], 0
    v_mfma_f32_16x16x32_bf16 v[100:103], v[64:67], v[24:27], v[100:103]
    s_waitcnt vmcnt(5)
    s_waitcnt lgkmcnt(0)
    s_barrier
    v_mfma_f32_16x16x32_bf16 v[92:95], v[28:31], v[24:27], 0
    ds_read_b64_tr_b16 v[44:45], v21 offset:16384
    s_add_u32 m0, s60, 0
    v_mfma_f32_16x16x32_bf16 v[76:79], v[28:31], a[0:3], 0
    ds_read_b64_tr_b16 v[46:47], v21 offset:16896
    s_mov_b32 s4, 0
    v_bfi_b32 v96, v22, s49, v96
    v_bfi_b32 v97, v22, s50, v97
    v_mfma_f32_16x16x32_bf16 v[80:83], v[28:31], a[4:7], 0
    buffer_load_dwordx4 v220, s[16:19], s4 offen  lds
    s_mov_b32 s4, 7168
    v_bfi_b32 v98, v22, s51, v98
    v_bfi_b32 v99, v22, s52, v99
    v_mfma_f32_16x16x32_bf16 v[84:87], v[28:31], a[8:11], 0
    ds_read_b64_tr_b16 v[48:49], v21 offset:17408
    buffer_store_dwordx4 v[96:99], v23, s[36:39], s101 offen sc1
    v_bfi_b32 v100, v22, s49, v100
    v_bfi_b32 v101, v22, s50, v101
    v_mfma_f32_16x16x32_bf16 v[88:91], v[28:31], a[12:15], 0
    ds_read_b64_tr_b16 v[50:51], v21 offset:17920
    v_bfi_b32 v102, v22, s51, v102
    v_bfi_b32 v103, v22, s52, v103
    buffer_store_dwordx4 v[100:103], v251, s[36:39], s101 offen offset:1024 sc1
    v_mfma_f32_16x16x32_bf16 v[92:95], v[32:35], v[24:27], v[92:95]
    ds_read_b64_tr_b16 v[52:53], v21 offset:18432
    v_mfma_f32_16x16x32_bf16 v[76:79], v[32:35], a[16:19], v[76:79]
    ds_read_b64_tr_b16 v[54:55], v21 offset:18944
    v_mfma_f32_16x16x32_bf16 v[80:83], v[32:35], a[20:23], v[80:83]
    buffer_load_dwordx4 v220, s[16:19], s4 offen offset:1024  lds
    s_mov_b32 s4, 14336
    v_mfma_f32_16x16x32_bf16 v[84:87], v[32:35], a[24:27], v[84:87]
    ds_read_b64_tr_b16 v[56:57], v21 offset:19456
    v_mfma_f32_16x16x32_bf16 v[88:91], v[32:35], a[28:31], v[88:91]
    ds_read_b64_tr_b16 v[58:59], v21 offset:19968
    v_mfma_f32_16x16x32_bf16 v[92:95], v[36:39], v[24:27], v[92:95]
    v_mfma_f32_16x16x32_bf16 v[76:79], v[36:39], a[32:35], v[76:79]
    v_mfma_f32_16x16x32_bf16 v[80:83], v[36:39], a[36:39], v[80:83]
    buffer_load_dwordx4 v220, s[16:19], s4 offen offset:2048  lds
    s_mov_b32 s4, 21504
    v_mfma_f32_16x16x32_bf16 v[84:87], v[36:39], a[40:43], v[84:87]
    v_mfma_f32_16x16x32_bf16 v[88:91], v[36:39], a[44:47], v[88:91]
    v_mfma_f32_16x16x32_bf16 v[92:95], v[40:43], v[24:27], v[92:95]
    v_mfma_f32_16x16x32_bf16 v[76:79], v[40:43], a[48:51], v[76:79]
    v_mfma_f32_16x16x32_bf16 v[80:83], v[40:43], a[52:55], v[80:83]
    buffer_load_dwordx4 v220, s[16:19], s4 offen offset:3072  lds
    v_mfma_f32_16x16x32_bf16 v[84:87], v[40:43], a[56:59], v[84:87]
    v_mfma_f32_16x16x32_bf16 v[88:91], v[40:43], a[60:63], v[88:91]
    s_waitcnt lgkmcnt(0)
    v_mfma_f32_16x16x32_bf16 v[92:95], v[44:47], v[24:27], v[92:95]
    ds_read_b64_tr_b16 v[28:29], v21 offset:32768
    s_add_u32 m0, s60, 16384
    v_mfma_f32_16x16x32_bf16 v[76:79], v[44:47], a[64:67], v[76:79]
    ds_read_b64_tr_b16 v[30:31], v21 offset:33280
    s_mov_b32 s4, 32768
    v_mfma_f32_16x16x32_bf16 v[80:83], v[44:47], a[68:71], v[80:83]
    buffer_load_dwordx4 v220, s[16:19], s4 offen  lds
    s_mov_b32 s4, 39936
    v_mfma_f32_16x16x32_bf16 v[84:87], v[44:47], a[72:75], v[84:87]
    ds_read_b64_tr_b16 v[32:33], v21 offset:33792
    v_mfma_f32_16x16x32_bf16 v[88:91], v[44:47], a[76:79], v[88:91]
    ds_read_b64_tr_b16 v[34:35], v21 offset:34304
    v_mfma_f32_16x16x32_bf16 v[92:95], v[48:51], v[24:27], v[92:95]
    ds_read_b64_tr_b16 v[36:37], v21 offset:34816
    v_mfma_f32_16x16x32_bf16 v[76:79], v[48:51], a[80:83], v[76:79]
    ds_read_b64_tr_b16 v[38:39], v21 offset:35328
    v_mfma_f32_16x16x32_bf16 v[80:83], v[48:51], a[84:87], v[80:83]
    s_branch L_pgo2
L_pg2:
    s_branch L_pgback1
L_pgo2:
    buffer_load_dwordx4 v220, s[16:19], s4 offen offset:1024  lds
    s_mov_b32 s4, 47104
    v_mfma_f32_16x16x32_bf16 v[84:87], v[48:51], a[88:91], v[84:87]
    ds_read_b64_tr_b16 v[40:41], v21 offset:35840
    v_mfma_f32_16x16x32_bf16 v[88:91], v[48:51], a[92:95], v[88:91]
    ds_read_b64_tr_b16 v[42:43], v21 offset:36352
    v_mfma_f32_16x16x32_bf16 v[92:95], v[52:55], v[24:27], v[92:95]
    ds_read2st64_b32 v[144:145], v248 offset0:0 offset1:4
    v_mfma_f32_16x16x32_bf16 v[76:79], v[52:55], a[96:99], v[76:79]
    v_xor_b32 v10, 256, v248
    v_mfma_f32_16x16x32_bf16 v[80:83], v[52:55], a[100:103], v[80:83]
    buffer_load_dwordx4 v220, s[16:19], s4 offen offset:2048  lds
    s_mov_b32 s4, 54272
    v_mfma_f32_16x16x32_bf16 v[84:87], v[52:55], a[104:107], v[84:87]
    ds_read2st64_b32 v[146:147], v10 offset0:0 offset1:4
    v_mfma_f32_16x16x32_bf16 v[88:91], v[52:55], a[108:111], v[88:91]
    v_xor_b32 v10, 512, v248
    v_mfma_f32_16x16x32_bf16 v[92:95], v[56:59], v[24:27], v[92:95]
    ds_read2st64_b32 v[148:149], v10 offset0:0 offset1:4
    v_mfma_f32_16x16x32_bf16 v[76:79], v[56:59], a[112:115], v[76:79]
    v_xor_b32 v10, 768, v248
    v_mfma_f32_16x16x32_bf16 v[80:83], v[56:59], a[116:119], v[80:83]
    buffer_load_dwordx4 v220, s[16:19], s4 offen offset:3072  lds
    v_mfma_f32_16x16x32_bf16 v[84:87], v[56:59], a[120:123], v[84:87]
    ds_read2st64_b32 v[150:151], v10 offset0:0 offset1:4
    v_mfma_f32_16x16x32_bf16 v[88:91], v[56:59], a[124:127], v[88:91]
    s_waitcnt lgkmcnt(0)
    v_mfma_f32_16x16x32_bf16 v[92:95], v[28:31], v[24:27], v[92:95]
    ds_read_b64_tr_b16 v[44:45], v21 offset:49152
    s_add_u32 m0, s60, 32768
    v_mfma_f32_16x16x32_bf16 v[76:79], v[28:31], a[128:131], v[76:79]
    ds_read_b64_tr_b16 v[46:47], v21 offset:49664
    s_mov_b32 s4, 65536
    v_mfma_f32_16x16x32_bf16 v[80:83], v[28:31], a[132:135], v[80:83]
    buffer_load_dwordx4 v220, s[16:19], s4 offen  lds
    s_mov_b32 s4, 72704
    v_mfma_f32_16x16x32_bf16 v[84:87], v[28:31], a[136:139], v[84:87]
    ds_read_b64_tr_b16 v[48:49], v21 offset:50176
    v_mfma_f32_16x16x32_bf16 v[88:91], v[28:31], a[140:143], v[88:91]
    ds_read_b64_tr_b16 v[50:51], v21 offset:50688
    v_mfma_f32_16x16x32_bf16 v[92:95], v[32:35], v[24:27], v[92:95]
    ds_read_b64_tr_b16 v[52:53], v21 offset:51200
    v_mfma_f32_16x16x32_bf16 v[76:79], v[32:35], a[144:147], v[76:79]
    ds_read_b64_tr_b16 v[54:55], v21 offset:51712
    v_mfma_f32_16x16x32_bf16 v[80:83], v[32:35], a[148:151], v[80:83]
    buffer_load_dwordx4 v220, s[16:19], s4 offen offset:1024  lds
    s_mov_b32 s4, 79872
    v_mfma_f32_16x16x32_bf16 v[84:87], v[32:35], a[152:155], v[84:87]
    ds_read_b64_tr_b16 v[56:57], v21 offset:52224
    v_mfma_f32_16x16x32_bf16 v[88:91], v[32:35], a[156:159], v[88:91]
    ds_read_b64_tr_b16 v[58:59], v21 offset:52736
    v_mfma_f32_16x16x32_bf16 v[92:95], v[36:39], v[24:27], v[92:95]
    v_mfma_f32_16x16x32_bf16 v[76:79], v[36:39], a[160:163], v[76:79]
    v_mfma_f32_16x16x32_bf16 v[80:83], v[36:39], a[164:167], v[80:83]
    buffer_load_dwordx4 v220, s[16:19], s4 offen offset:2048  lds
    s_mov_b32 s4, 87040
    v_mfma_f32_16x16x32_bf16 v[84:87], v[36:39], a[168:171], v[84:87]
    v_mfma_f32_16x16x32_bf16 v[88:91], v[36:39], a[172:175], v[88:91]
    v_mfma_f32_16x16x32_bf16 v[92:95], v[40:43], v[24:27], v[92:95]
    v_mfma_f32_16x16x32_bf16 v[76:79], v[40:43], a[176:179], v[76:79]
    v_mfma_f32_16x16x32_bf16 v[80:83], v[40:43], a[180:183], v[80:83]
    buffer_load_dwordx4 v220, s[16:19], s4 offen offset:3072  lds
    v_mfma_f32_16x16x32_bf16 v[84:87], v[40:43], a[184:187], v[84:87]
    v_mfma_f32_16x16x32_bf16 v[88:91], v[40:43], a[188:191], v[88:91]
    s_waitcnt lgkmcnt(0)
    s_barrier
    v_mfma_f32_16x16x32_bf16 v[92:95], v[44:47], v[24:27], v[92:95]
    s_add_u32 m0, s60, 49152
    s_mov_b32 s4, 98304
    v_mfma_f32_16x16x32_bf16 v[76:79], v[44:47], a[192:195], v[76:79]
    buffer_load_dwordx4 v220, s[16:19], s4 offen  lds
    s_mov_b32 s4, 105472
    v_mfma_f32_16x16x32_bf16 v[80:83], v[44:47], a[196:199], v[80:83]
    v_mfma_f32_16x16x32_bf16 v[84:87], v[44:47], a[200:203], v[84:87]
    buffer_load_dwordx4 v220, s[16:19], s4 offen offset:1024  lds
    s_mov_b32 s4, 112640
    v_mfma_f32_16x16x32_bf16 v[88:91], v[44:47], a[204:207], v[88:91]
    v_mfma_f32_16x16x32_bf16 v[92:95], v[48:51], v[24:27], v[92:95]
    v_mfma_f32_16x16x32_bf16 v[76:79], v[48:51], a[208:211], v[76:79]
    buffer_load_dwordx4 v220, s[16:19], s4 offen offset:2048  lds
    s_mov_b32 s4, 119808
    v_mfma_f32_16x16x32_bf16 v[80:83], v[48:51], a[212:215], v[80:83]
    v_mfma_f32_16x16x32_bf16 v[84:87], v[48:51], a[216:219], v[84:87]
    buffer_load_dwordx4 v220, s[16:19], s4 offen offset:3072  lds
    v_mfma_f32_16x16x32_bf16 v[88:91], v[48:51], a[220:223], v[88:91]
    v_mfma_f32_16x16x32_bf16 v[92:95], v[52:55], v[24:27], v[92:95]
    v_mfma_f32_16x16x32_bf16 v[76:79], v[52:55], a[224:227], v[76:79]
    buffer_load_dwordx4 v[112:115], v253, s[36:39], s24 offen offset:0 sc1
    v_mfma_f32_16x16x32_bf16 v[80:83], v[52:55], a[228:231], v[80:83]
    v_mfma_f32_16x16x32_bf16 v[84:87], v[52:55], a[232:235], v[84:87]
    buffer_load_dwordx4 v[116:119], v253, s[36:39], s24 offen offset:1152 sc1
    v_mfma_f32_16x16x32_bf16 v[88:91], v[52:55], a[236:239], v[88:91]
    v_mfma_f32_16x16x32_bf16 v[92:95], v[56:59], v[24:27], v[92:95]
    v_mfma_f32_16x16x32_bf16 v[76:79], v[56:59], a[240:243], v[76:79]
    buffer_load_dwordx4 v[120:123], v253, s[36:39], s24 offen offset:2304 sc1
    v_mfma_f32_16x16x32_bf16 v[80:83], v[56:59], a[244:247], v[80:83]
    v_mfma_f32_16x16x32_bf16 v[84:87], v[56:59], a[248:251], v[84:87]
    buffer_load_dwordx4 v[124:127], v253, s[36:39], s24 offen offset:3456 sc1
    v_mfma_f32_16x16x32_bf16 v[88:91], v[56:59], a[252:255], v[88:91]
    s_nop 2
    v_pk_fma_f32 v[76:77], v[144:145], v[92:93], v[76:77] op_sel_hi:[0,1,1] neg_lo:[1,0,0] neg_hi:[1,0,0]
    v_pk_fma_f32 v[78:79], v[144:145], v[94:95], v[78:79] op_sel_hi:[0,1,1] neg_lo:[1,0,0] neg_hi:[1,0,0]
    v_pk_fma_f32 v[80:81], v[146:147], v[92:93], v[80:81] op_sel_hi:[0,1,1] neg_lo:[1,0,0] neg_hi:[1,0,0]
    v_pk_fma_f32 v[82:83], v[146:147], v[94:95], v[82:83] op_sel_hi:[0,1,1] neg_lo:[1,0,0] neg_hi:[1,0,0]
    v_pk_fma_f32 v[84:85], v[148:149], v[92:93], v[84:85] op_sel_hi:[0,1,1] neg_lo:[1,0,0] neg_hi:[1,0,0]
    s_mov_b32 s96, 32768
    buffer_load_dwordx4 v[240:243], v223, s[8:11], 0 offen
    v_pk_fma_f32 v[86:87], v[148:149], v[94:95], v[86:87] op_sel_hi:[0,1,1] neg_lo:[1,0,0] neg_hi:[1,0,0]
    v_pk_fma_f32 v[88:89], v[150:151], v[92:93], v[88:89] op_sel_hi:[0,1,1] neg_lo:[1,0,0] neg_hi:[1,0,0]
    v_pk_fma_f32 v[90:91], v[150:151], v[94:95], v[90:91] op_sel_hi:[0,1,1] neg_lo:[1,0,0] neg_hi:[1,0,0]
    v_pk_mul_f32 v[76:77], v[144:145], v[76:77] op_sel:[1,0]
    v_pk_mul_f32 v[78:79], v[144:145], v[78:79] op_sel:[1,0]
    v_pk_mul_f32 v[80:81], v[146:147], v[80:81] op_sel:[1,0]
    v_pk_mul_f32 v[82:83], v[146:147], v[82:83] op_sel:[1,0]
    v_pk_mul_f32 v[84:85], v[148:149], v[84:85] op_sel:[1,0]
    v_pk_mul_f32 v[86:87], v[148:149], v[86:87] op_sel:[1,0]
    v_pk_mul_f32 v[88:89], v[150:151], v[88:89] op_sel:[1,0]
    v_pk_mul_f32 v[90:91], v[150:151], v[90:91] op_sel:[1,0]
    v_pk_mul_f32 v[192:193], v[76:77], s[56:57]
    v_pk_mul_f32 v[194:195], v[78:79], s[56:57]
    v_pk_mul_f32 v[196:197], v[80:81], s[56:57]
    v_pk_mul_f32 v[198:199], v[82:83], s[56:57]
    v_pk_mul_f32 v[200:201], v[84:85], s[56:57]
    buffer_load_dwordx4 v[244:247], v223, s[8:11], s96 offen
    v_pk_mul_f32 v[202:203], v[86:87], s[56:57]
    v_pk_mul_f32 v[204:205], v[88:89], s[56:57]
    v_pk_mul_f32 v[206:207], v[90:91], s[56:57]
    v_exp_f32 v192, v192 clamp
    v_max_f32 v76, 0x358637bd, v76
    v_exp_f32 v193, v193 clamp
    v_max_f32 v77, 0x358637bd, v77
    v_exp_f32 v194, v194 clamp
    v_max_f32 v78, 0x358637bd, v78
    v_exp_f32 v195, v195 clamp
    v_max_f32 v79, 0x358637bd, v79
    v_exp_f32 v196, v196 clamp
    s_add_u32 s96, s1, 1
    s_and_b32 s96, s96, 15
    s_add_u32 m0, s6, 139264
    s_mul_i32 s96, s96, 88064
    buffer_load_dwordx4 v224, s[20:23], s96 offen  lds
    v_max_f32 v80, 0x358637bd, v80
    v_exp_f32 v197, v197 clamp
    v_max_f32 v81, 0x358637bd, v81
    v_exp_f32 v198, v198 clamp
    v_max_f32 v82, 0x358637bd, v82
    v_exp_f32 v199, v199 clamp
    v_max_f32 v83, 0x358637bd, v83
    v_exp_f32 v200, v200 clamp
    v_max_f32 v84, 0x358637bd, v84
    v_exp_f32 v201, v201 clamp
    buffer_load_dwordx4 v225, s[20:23], s96 offen offset:1024  lds
    v_max_f32 v85, 0x358637bd, v85
    v_exp_f32 v202, v202 clamp
    v_max_f32 v86, 0x358637bd, v86
    v_exp_f32 v203, v203 clamp
    v_max_f32 v87, 0x358637bd, v87
    v_exp_f32 v204, v204 clamp
    v_max_f32 v88, 0x358637bd, v88
    v_exp_f32 v205, v205 clamp
    v_max_f32 v89, 0x358637bd, v89
    v_exp_f32 v206, v206 clamp
    v_max_f32 v90, 0x358637bd, v90
    buffer_load_dwordx4 v226, s[20:23], s96 offen offset:2048  lds
    v_exp_f32 v207, v207 clamp
    v_max_f32 v91, 0x358637bd, v91
    v_pk_add_f32 v[76:77], v[76:77], v[192:193]
    v_pk_add_f32 v[78:79], v[78:79], v[194:195]
    v_pk_add_f32 v[80:81], v[80:81], v[196:197]
    v_pk_add_f32 v[82:83], v[82:83], v[198:199]
    v_pk_add_f32 v[84:85], v[84:85], v[200:201]
    v_pk_add_f32 v[86:87], v[86:87], v[202:203]
    v_pk_add_f32 v[88:89], v[88:89], v[204:205]
    v_pk_add_f32 v[90:91], v[90:91], v[206:207]
    v_cvt_pk_bf16_f32 v208, v76, v77
    v_cvt_pk_bf16_f32 v209, v78, v79
    v_cvt_pk_bf16_f32 v210, v80, v81
    v_cvt_pk_bf16_f32 v211, v82, v83
    v_cvt_pk_bf16_f32 v212, v84, v85
    v_cvt_pk_bf16_f32 v213, v86, v87
    v_cvt_pk_bf16_f32 v214, v88, v89
    v_cvt_pk_bf16_f32 v215, v90, v91
    v_xor_b32 v11, 0x400, v250
    v_permlane16_swap_b32 v208, v210
    v_permlane16_swap_b32 v209, v211
    buffer_store_dwordx4 v[208:211], v250, s[36:39], s100 offen sc1
    v_permlane16_swap_b32 v212, v214
    v_permlane16_swap_b32 v213, v215
    buffer_store_dwordx4 v[212:215], v11, s[36:39], s100 offen sc1
    s_mov_b32 s59, 2130706432
    s_mov_b32 s5, 1
    s_cmp_eq_u32 s48, 0
    s_cselect_b32 s101, -1, 0
    s_waitcnt vmcnt(7)
    s_cmp_eq_u32 s26, 0
    s_cbranch_scc1 L_skip1
    v_bitop3_b32 v112, v112, v22, s49 bitop3:0x78
    v_bitop3_b32 v113, v113, v22, s50 bitop3:0x78
    v_or_b32 v128, v112, v113
    v_bitop3_b32 v114, v114, v22, s51 bitop3:0x78
    v_bitop3_b32 v115, v115, v22, s52 bitop3:0x78
    v_or3_b32 v128, v128, v114, v115
    v_bitop3_b32 v116, v116, v22, s49 bitop3:0x78
    v_bitop3_b32 v117, v117, v22, s50 bitop3:0x78
    v_or3_b32 v128, v128, v116, v117
    v_bitop3_b32 v118, v118, v22, s51 bitop3:0x78
    v_bitop3_b32 v119, v119, v22, s52 bitop3:0x78
    v_or3_b32 v128, v128, v118, v119
    v_bitop3_b32 v120, v120, v22, s49 bitop3:0x78
    v_bitop3_b32 v121, v121, v22, s50 bitop3:0x78
    v_or3_b32 v128, v128, v120, v121
    v_bitop3_b32 v122, v122, v22, s51 bitop3:0x78
    v_bitop3_b32 v123, v123, v22, s52 bitop3:0x78
    v_or3_b32 v128, v128, v122, v123
    v_bitop3_b32 v124, v124, v22, s49 bitop3:0x78
    v_bitop3_b32 v125, v125, v22, s50 bitop3:0x78
    v_or3_b32 v128, v128, v124, v125
    v_bitop3_b32 v126, v126, v22, s51 bitop3:0x78
    v_bitop3_b32 v127, v127, v22, s52 bitop3:0x78
    v_or3_b32 v128, v128, v126, v127
    v_and_b32 v128, 0xff, v128
    v_cmp_ne_u32 vcc, 0, v128
    s_nop 1
    s_cbranch_vccnz L_jf2
    v_pk_add_f32 v[112:113], v[112:113], v[120:121]
    v_pk_add_f32 v[114:115], v[114:115], v[122:123]
    v_pk_add_f32 v[116:117], v[116:117], v[124:125]
    v_pk_add_f32 v[118:119], v[118:119], v[126:127]
    v_pk_add_f32 v[112:113], v[112:113], v[116:117]
    v_pk_add_f32 v[114:115], v[114:115], v[118:119]
    s_nop 0
    v_permlane16_swap_b32 v112, v113
    v_permlane16_swap_b32 v114, v115
    v_add_f32 v112, v112, v113
    v_add_f32 v114, v114, v115
    v_mov_b32 v129, s49
    s_mov_b32 vcc_lo, s7
    v_permlane32_swap_b32 v112, v114
    v_add_f32 v112, v112, v114
    s_mov_b32 vcc_hi, s7
    s_nop 0
    v_add_f32_dpp v113, v112, v112 row_ror:8 row_mask:0xf bank_mask:0xf
    v_add_f32_dpp v112, v112, v112 row_ror:8 row_mask:0xf bank_mask:0xf
    s_nop 1
    v_permlane16_swap_b32 v112, v113
    v_cvt_pk_bf16_f32 v132, v112, v113
    v_cvt_pk_bf16_f32 v135, v112, v113
    s_nop 1
    v_permlane32_swap_b32 v132, v135
    v_cndmask_b32 v133, v129, v135, vcc
    v_cndmask_b32 v134, v132, v129, vcc
    s_mov_b32 s26, 0
    s_mov_b32 s59, s25
    s_mov_b32 s24, 2130706432
L_jf2:
L_skip1:
    buffer_store_dwordx4 v[132:135], v221, s[36:39], s59 offen sc1
    buffer_load_dwordx4 v[112:115], v253, s[36:39], s24 offen offset:0 sc1
    buffer_load_dwordx4 v[116:119], v253, s[36:39], s24 offen offset:1152 sc1
    buffer_load_dwordx4 v[120:123], v253, s[36:39], s24 offen offset:2304 sc1
    buffer_load_dwordx4 v[124:127], v253, s[36:39], s24 offen offset:3456 sc1
    ds_read_b64_tr_b16 a[192:193], v236 offset:0
    ds_read_b64_tr_b16 a[194:195], v236 offset:1024
    ds_read_b64_tr_b16 a[196:197], v237 offset:0
    ds_read_b64_tr_b16 a[198:199], v237 offset:1024
    s_add_u32 s96, s1, 2
    s_and_b32 s96, s96, 15
    s_add_u32 m0, s6, 126976
    s_mul_i32 s96, s96, 88064
    buffer_load_dwordx4 v224, s[20:23], s96 offen  lds
    ds_read_b64_tr_b16 a[200:201], v236 offset:2048
    ds_read_b64_tr_b16 a[202:203], v236 offset:3072
    ds_read_b64_tr_b16 a[204:205], v237 offset:2048
    ds_read_b64_tr_b16 a[206:207], v237 offset:3072
    ds_read_b64_tr_b16 a[208:209], v236 offset:16384
    ds_read_b64_tr_b16 a[210:211], v236 offset:17408
    ds_read_b64_tr_b16 a[212:213], v237 offset:16384
    ds_read_b64_tr_b16 a[214:215], v237 offset:17408
    ds_read_b64_tr_b16 a[216:217], v236 offset:18432
    ds_read_b64_tr_b16 a[218:219], v236 offset:19456
    ds_read_b64_tr_b16 a[220:221], v237 offset:18432
    ds_read_b64_tr_b16 a[222:223], v237 offset:19456
    ds_read_b64_tr_b16 a[224:225], v236 offset:32768
    buffer_load_dwordx4 v225, s[20:23], s96 offen offset:1024  lds
    ds_read_b64_tr_b16 a[226:227], v236 offset:33792
    ds_read_b64_tr_b16 a[228:229], v237 offset:32768
    ds_read_b64_tr_b16 a[230:231], v237 offset:33792
    ds_read_b64_tr_b16 a[232:233], v236 offset:34816
    ds_read_b64_tr_b16 a[234:235], v236 offset:35840
    ds_read_b64_tr_b16 a[236:237], v237 offset:34816
    ds_read_b64_tr_b16 a[238:239], v237 offset:35840
    ds_read_b64_tr_b16 a[240:241], v236 offset:49152
    ds_read_b64_tr_b16 a[242:243], v236 offset:50176
    ds_read_b64_tr_b16 a[244:245], v237 offset:49152
    ds_read_b64_tr_b16 a[246:247], v237 offset:50176
    ds_read_b64_tr_b16 a[248:249], v236 offset:51200
    ds_read_b64_tr_b16 a[250:251], v236 offset:52224
    buffer_load_dwordx4 v226, s[20:23], s96 offen offset:2048  lds
    ds_read_b64_tr_b16 a[252:253], v237 offset:51200
    ds_read_b64_tr_b16 a[254:255], v237 offset:52224
    s_lshr_b32 s54, s43, 1
    s_lshl2_add_u32 s54, s42, s54
    s_lshl_b32 s54, s54, 8
    s_and_b32 s55, s43, 1
    s_lshl2_add_u32 s54, s55, s54
    s_add_u32 s57, s54, 26624
    s_waitcnt vmcnt(8)
    s_waitcnt lgkmcnt(0)
    s_barrier
    s_cmp_lg_u32 s48, 3
    s_cbranch_scc1 L_skip3
    s_atomic_swap s49, s[36:37], s57
L_skip3:
    s_cmp_eq_u32 s26, 0
    s_cbranch_scc1 L_skip4
    s_mov_b32 s61, 0
    s_waitcnt vmcnt(3)
    s_branch L_kvp5_c
L_kvp5:
    buffer_load_dwordx4 v[112:115], v253, s[36:39], s24 offen offset:0 sc1
    buffer_load_dwordx4 v[116:119], v253, s[36:39], s24 offen offset:1152 sc1
    buffer_load_dwordx4 v[120:123], v253, s[36:39], s24 offen offset:2304 sc1
    buffer_load_dwordx4 v[124:127], v253, s[36:39], s24 offen offset:3456 sc1
    s_waitcnt vmcnt(0)
L_kvp5_c:
    s_add_u32 s61, s61, 1
    s_cmp_gt_u32 s61, 400000
    v_bitop3_b32 v112, v112, v22, s49 bitop3:0x78
    v_bitop3_b32 v113, v113, v22, s50 bitop3:0x78
    v_or_b32 v128, v112, v113
    v_bitop3_b32 v114, v114, v22, s51 bitop3:0x78
    v_bitop3_b32 v115, v115, v22, s52 bitop3:0x78
    v_or3_b32 v128, v128, v114, v115
    v_bitop3_b32 v116, v116, v22, s49 bitop3:0x78
    v_bitop3_b32 v117, v117, v22, s50 bitop3:0x78
    v_or3_b32 v128, v128, v116, v117
    v_bitop3_b32 v118, v118, v22, s51 bitop3:0x78
    v_bitop3_b32 v119, v119, v22, s52 bitop3:0x78
    v_or3_b32 v128, v128, v118, v119
    v_bitop3_b32 v120, v120, v22, s49 bitop3:0x78
    v_bitop3_b32 v121, v121, v22, s50 bitop3:0x78
    v_or3_b32 v128, v128, v120, v121
    v_bitop3_b32 v122, v122, v22, s51 bitop3:0x78
    v_bitop3_b32 v123, v123, v22, s52 bitop3:0x78
    v_or3_b32 v128, v128, v122, v123
    v_bitop3_b32 v124, v124, v22, s49 bitop3:0x78
    v_bitop3_b32 v125, v125, v22, s50 bitop3:0x78
    v_or3_b32 v128, v128, v124, v125
    v_bitop3_b32 v126, v126, v22, s51 bitop3:0x78
    v_bitop3_b32 v127, v127, v22, s52 bitop3:0x78
    v_or3_b32 v128, v128, v126, v127
    v_and_b32 v128, 0xff, v128
    v_cmp_ne_u32 vcc, 0, v128
    s_cbranch_scc1 L_kvpok6
    s_nop 0
    s_cbranch_vccnz L_kvp5
L_kvpok6:
    v_pk_add_f32 v[112:113], v[112:113], v[120:121]
    v_pk_add_f32 v[114:115], v[114:115], v[122:123]
    v_pk_add_f32 v[116:117], v[116:117], v[124:125]
    v_pk_add_f32 v[118:119], v[118:119], v[126:127]
    v_pk_add_f32 v[112:113], v[112:113], v[116:117]
    v_pk_add_f32 v[114:115], v[114:115], v[118:119]
    s_nop 0
    v_permlane16_swap_b32 v112, v113
    v_permlane16_swap_b32 v114, v115
    v_add_f32 v112, v112, v113
    v_add_f32 v114, v114, v115
    v_mov_b32 v129, s49
    s_mov_b32 vcc_lo, s7
    v_permlane32_swap_b32 v112, v114
    v_add_f32 v112, v112, v114
    s_mov_b32 vcc_hi, s7
    s_nop 0
    v_add_f32_dpp v113, v112, v112 row_ror:8 row_mask:0xf bank_mask:0xf
    v_add_f32_dpp v112, v112, v112 row_ror:8 row_mask:0xf bank_mask:0xf
    s_nop 1
    v_permlane16_swap_b32 v112, v113
    v_cvt_pk_bf16_f32 v132, v112, v113
    v_cvt_pk_bf16_f32 v135, v112, v113
    s_nop 1
    v_permlane32_swap_b32 v132, v135
    v_cndmask_b32 v133, v129, v135, vcc
    v_cndmask_b32 v134, v132, v129, vcc
    buffer_store_dwordx4 v[132:135], v221, s[36:39], s25 offen sc1
L_skip4:
    v_lshrrev_b32 v9, 5, v1
    v_lshlrev_b32 v8, 9, v9
    v_lshl_or_b32 v8, v3, 4, v8
    s_add_u32 m0, s53, 32768
    s_mov_b32 s96, 0
    s_movk_i32 s97, 7168
    buffer_load_dwordx4 v229, s[28:31], s96 offen  lds
    v_add_u32 v10, 0x100, v8
    v_lshlrev_b32 v9, 5, v9
    v_add_u32 v9, 0x400, v9
    v_add_u32 v11, 16, v9
    s_mov_b32 vcc_lo, 0xffff0000
    s_mov_b32 vcc_hi, 0xffff0000
    v_cndmask_b32 v18, v8, v9, vcc
    v_cndmask_b32 v19, v10, v11, vcc
    s_lshl2_add_u32 s54, s40, s48
    buffer_load_dwordx4 v229, s[28:31], s97 offen offset:1024  lds
    s_mul_i32 s54, s54, 9216
    s_add_u32 s8, s54, 1835008
    s_add_u32 s9, s8, 3456
    s_add_u32 s10, s8, 6912
    s_lshl2_add_u32 s54, s44, s48
    s_lshl_b32 s11, s54, 8
    s_add_u32 s11, s11, 26624
    s_lshl_b32 s54, s54, 14
    s_add_u32 s96, s1, 3
    s_and_b32 s96, s96, 15
    s_add_u32 m0, s6, 114688
    s_mul_i32 s96, s96, 88064
    buffer_load_dwordx4 v224, s[20:23], s96 offen  lds
    s_add_u32 s14, s54, 2162688
    s_and_b32 s55, s44, 1
    s_lshr_b32 s56, s48, 1
    s_lshl2_add_u32 s54, s27, s56
    s_lshl1_add_u32 s54, s54, s55
    s_lshl_b32 s54, s54, 14
    s_add_u32 s12, s54, 7208960
    s_mov_b32 s56, s27
    s_lshl_b32 s54, s45, 1
    buffer_load_dwordx4 v225, s[20:23], s96 offen offset:1024  lds
    s_sub_u32 s54, s54, s56
    s_and_b32 s56, s48, 1
    s_lshl3_add_u32 s56, s54, s56
    s_lshl_b32 s56, s56, 7
    v_and_b32 v9, 7, v1
    v_lshrrev_b32 v10, 3, v1
    v_lshl_add_u32 v16, v9, 8, s56
    v_and_b32 v16, 0x3fff, v16
    v_lshl_or_b32 v16, v10, 4, v16
    buffer_load_dwordx4 v226, s[20:23], s96 offen offset:2048  lds
    v_lshlrev_b32 v17, 3, v10
    v_lshl_or_b32 v17, v9, 28, v17
    s_lshl3_add_u32 s54, s27, s45
    s_lshr_b32 s56, s48, 1
    s_lshl2_add_u32 s54, s54, s56
    s_lshl1_add_u32 s54, s54, s55
    s_and_b32 s56, s48, 1
    s_lshl1_add_u32 s54, s54, s56
    s_add_u32 s96, s1, 4
    s_and_b32 s96, s96, 15
    s_add_u32 m0, s6, 102400
    s_mul_i32 s96, s96, 88064
    buffer_load_dwordx4 v224, s[20:23], s96 offen  lds
    s_lshl_b32 s54, s54, 6
    s_add_u32 s13, s54, 262144
    v_xor_b32 v12, 32, v234
    v_xor_b32 v13, 64, v234
    v_xor_b32 v14, 96, v234
    v_xor_b32 v15, 16, v235
    s_mov_b64 s[62:63], 0
    s_atomic_or_x2 s[62:63], s[36:37], s11 glc
    s_lshl_b32 s3, s46, 17
    s_add_u32 s3, s3, 7208960
    s_add_u32 s3, s3, s60
    s_add_u32 s96, s1, 4
    s_and_b32 s96, s96, 15
    s_add_u32 m0, s6, 102400
    s_mul_i32 s96, s96, 88064
    buffer_load_dwordx4 v225, s[20:23], s96 offen offset:1024  lds
    s_cmp_eq_u32 s47, 15
    s_cselect_b32 s3, 2130706432, s3
    v_add_u32 v4, 0x10000, v23
    v_add_u32 v5, 131072, v23
    s_lshl_b32 s55, s48, 10
    v_add_u32 v21, s55, v5
    s_mul_i32 s54, s46, 360448
    s_add_u32 s54, s54, 9306112
    s_mul_i32 s55, s47, 3
    s_lshr_b32 s56, s48, 1
    buffer_load_dwordx4 v226, s[20:23], s96 offen offset:2048  lds
    s_add_u32 s56, s55, s56
    s_and_b32 s57, s56, 3
    s_mul_i32 s57, s57, 11
    s_lshr_b32 s58, s56, 2
    s_add_u32 s57, s57, s58
    s_lshl_b32 s57, s57, 10
    s_add_u32 s4, s54, s57
    s_cmp_ge_u32 s56, 44
    s_cselect_b32 s4, 2130706432, s4
    s_add_u32 s56, s55, 2
    s_add_u32 s96, s1, 5
    s_and_b32 s96, s96, 15
    s_add_u32 m0, s6, 90112
    s_mul_i32 s96, s96, 88064
    buffer_load_dwordx4 v224, s[20:23], s96 offen  lds
    s_and_b32 s57, s56, 3
    s_mul_i32 s57, s57, 11
    s_lshr_b32 s58, s56, 2
    s_add_u32 s57, s57, s58
    s_lshl_b32 s57, s57, 10
    s_add_u32 s15, s54, s57
    s_cmp_ge_u32 s56, 44
    s_cselect_b32 s15, 2130706432, s15
    s_lshl_b32 s58, s48, 8
    buffer_load_dwordx4 v225, s[20:23], s96 offen offset:1024  lds
    v_lshrrev_b32 v9, 5, v1
    v_lshl_or_b32 v6, v3, 4, s58
    v_lshl_or_b32 v6, v9, 3, v6
    v_and_b32 v8, 1, v2
    v_mul_u32_u24 v8, 180224, v8
    v_add_u32 v6, v8, v6
    v_add_u32 v20, v8, v20
    s_lshl2_add_u32 s16, s45, s48
    s_mul_i32 s16, s16, 45056
    s_add_u32 s16, s16, 4259840
    buffer_load_dwordx4 v226, s[20:23], s96 offen offset:2048  lds
    s_lshl_b32 s17, s46, 13
    s_lshl_b32 s55, s48, 7
    s_add_u32 s17, s17, s55
    s_add_u32 s17, s17, 262144
    v_lshlrev_b32 v7, 11, v2
    v_lshl_or_b32 v7, v3, 3, v7
    s_cmp_eq_u32 s48, 0
    s_cbranch_scc1 L_pg5
    s_cmp_eq_u32 s48, 1
    s_cbranch_scc1 L_pg6
    s_cmp_eq_u32 s48, 2
    s_cbranch_scc1 L_pg7
    s_branch L_pg8
L_pgback5:
    s_mov_b32 s61, 0
    s_waitcnt lgkmcnt(0)
    s_branch L_sp7_t
L_sp7:
    s_mov_b64 s[62:63], 0
    s_atomic_or_x2 s[62:63], s[36:37], s11 glc
    s_add_u32 s61, s61, 1
    s_cmp_gt_u32 s61, 400000
    s_waitcnt lgkmcnt(0)
    s_cbranch_scc1 L_spe8
L_sp7_t:
    s_cmp_lg_u32 s62, s49
    s_cbranch_scc1 L_sp7
    s_cmp_lg_u32 s63, s49
    s_cbranch_scc1 L_sp7
L_spe8:
    s_add_u32 s97, s14, 0
    buffer_load_dwordx4 a[128:131], v23, s[36:39], s97 offen offset:0 sc1
    buffer_load_dwordx4 v[28:31], v18, s[36:39], s8 offen offset:0 sc1
    buffer_load_dwordx3 v[32:34], v19, s[36:39], s8 offen offset:0 sc1
    buffer_load_dwordx4 a[132:135], v23, s[36:39], s97 offen offset:2048 sc1
    buffer_load_dwordx4 v[36:39], v18, s[36:39], s8 offen offset:1152 sc1
    buffer_load_dwordx3 v[40:42], v19, s[36:39], s8 offen offset:1152 sc1
    s_add_u32 s97, s14, 4096
    buffer_load_dwordx4 a[136:139], v23, s[36:39], s97 offen offset:0 sc1
    buffer_load_dwordx4 v[44:47], v18, s[36:39], s8 offen offset:2304 sc1
    buffer_load_dwordx3 v[48:50], v19, s[36:39], s8 offen offset:2304 sc1
    buffer_load_dwordx4 a[140:143], v23, s[36:39], s97 offen offset:2048 sc1
    buffer_load_dwordx4 v[52:55], v18, s[36:39], s9 offen offset:0 sc1
    buffer_load_dwordx3 v[56:58], v19, s[36:39], s9 offen offset:0 sc1
    s_waitcnt vmcnt(12)
    s_waitcnt lgkmcnt(0)
    s_barrier
    ds_read_b64_tr_b16 v[200:201], v232 offset:0
    ds_read_b64_tr_b16 v[202:203], v232 offset:512
    ds_read_b64_tr_b16 v[204:205], v233 offset:0
    ds_read_b64_tr_b16 v[206:207], v233 offset:512
    ds_read_b64_tr_b16 a[0:1], v254 offset:49152
    ds_read_b64_tr_b16 a[4:5], v254 offset:55296
    ds_read_b64_tr_b16 a[8:9], v255 offset:49152
    ds_read_b64_tr_b16 a[2:3], v254 offset:49920
    ds_read_b64_tr_b16 a[6:7], v254 offset:56064
    ds_read_b64_tr_b16 a[10:11], v255 offset:49920
    ds_read_b64_tr_b16 a[12:13], v254 offset:36864
    ds_read_b64_tr_b16 a[16:17], v254 offset:43008
    ds_read_b64_tr_b16 a[20:21], v255 offset:36864
    ds_read_b64_tr_b16 a[14:15], v254 offset:37632
    ds_read_b64_tr_b16 a[18:19], v254 offset:43776
    ds_read_b64_tr_b16 a[22:23], v255 offset:37632
    ds_read_b64_tr_b16 a[24:25], v254 offset:24576
    ds_read_b64_tr_b16 a[28:29], v254 offset:30720
    ds_read_b64_tr_b16 a[32:33], v255 offset:24576
    ds_read_b64_tr_b16 a[26:27], v254 offset:25344
    ds_read_b64_tr_b16 a[30:31], v254 offset:31488
    ds_read_b64_tr_b16 a[34:35], v255 offset:25344
    ds_read_b64_tr_b16 a[36:37], v254 offset:12288
    ds_read_b64_tr_b16 a[40:41], v254 offset:18432
    ds_read_b64_tr_b16 a[44:45], v255 offset:12288
    ds_read_b64_tr_b16 a[38:39], v254 offset:13056
    ds_read_b64_tr_b16 a[42:43], v254 offset:19200
    ds_read_b64_tr_b16 a[46:47], v255 offset:13056
    s_waitcnt vmcnt(9)
    v_bitop3_b32 v9, v29, v34, s49 bitop3:0x7e
    v_cmp_ne_u32 vcc, 0, v9
    s_nop 1
    s_cbranch_vccnz L_cold11
L_cold11_r:
    v_mfma_f32_32x32x16_bf16 v[156:171], v[30:33], a[128:131], 0
    s_add_u32 s97, s14, 8192
    buffer_load_dwordx4 a[144:147], v23, s[36:39], s97 offen offset:0 sc1
    buffer_load_dwordx4 v[60:63], v18, s[36:39], s9 offen offset:1152 sc1
    buffer_load_dwordx3 v[64:66], v19, s[36:39], s9 offen offset:1152 sc1
    s_waitcnt vmcnt(9)
    v_bitop3_b32 v9, v37, v42, s49 bitop3:0x7e
    v_cmp_ne_u32 vcc, 0, v9
    s_nop 1
    s_cbranch_vccnz L_cold12
L_cold12_r:
    v_mfma_f32_32x32x16_bf16 v[172:187], v[38:41], a[132:135], 0
    buffer_load_dwordx4 a[148:151], v23, s[36:39], s97 offen offset:2048 sc1
    buffer_load_dwordx4 v[68:71], v18, s[36:39], s9 offen offset:2304 sc1
    buffer_load_dwordx3 v[72:74], v19, s[36:39], s9 offen offset:2304 sc1
    v_add_f32 v164, 0x358637bd, v164
    v_rcp_f32 v164, v164
    s_nop 0
    v_mul_f32 v156, v164, v156
    v_mul_f32 v157, v164, v157
    v_mul_f32 v158, v164, v158
    v_mul_f32 v159, v164, v159
    v_cvt_pk_bf16_f32 v188, v156, v157
    v_mul_f32 v160, v164, v160
    v_mul_f32 v161, v164, v161
    v_cvt_pk_bf16_f32 v189, v158, v159
    v_mul_f32 v162, v164, v162
    v_mul_f32 v163, v164, v163
    v_cvt_pk_bf16_f32 v190, v160, v161
    v_cvt_pk_bf16_f32 v191, v162, v163
    s_branch L_pgo3
L_pg3:
    s_branch L_pgback1
L_pgo3:
    s_waitcnt vmcnt(9)
    v_bitop3_b32 v9, v45, v50, s49 bitop3:0x7e
    v_cmp_ne_u32 vcc, 0, v9
    s_nop 1
    s_cbranch_vccnz L_cold13
L_cold13_r:
    v_mfma_f32_32x32x16_bf16 v[156:171], v[46:49], a[136:139], 0
    s_add_u32 s97, s14, 12288
    buffer_load_dwordx4 a[152:155], v23, s[36:39], s97 offen offset:0 sc1
    buffer_load_dwordx4 v[76:79], v18, s[36:39], s10 offen offset:0 sc1
    buffer_load_dwordx3 v[80:82], v19, s[36:39], s10 offen offset:0 sc1
    v_add_f32 v180, 0x358637bd, v180
    v_rcp_f32 v180, v180
    v_mfma_f32_32x32x16_bf16 v[92:107], a[192:195], v[188:191], 0
    v_mul_f32 v172, v180, v172
    v_mul_f32 v173, v180, v173
    v_mul_f32 v174, v180, v174
    v_mul_f32 v175, v180, v175
    v_cvt_pk_bf16_f32 v192, v172, v173
    v_mul_f32 v176, v180, v176
    ds_read_b64_tr_b16 a[48:49], v254 offset:0
    v_mfma_f32_32x32x16_bf16 v[108:123], a[196:199], v[188:191], 0
    v_mul_f32 v177, v180, v177
    v_cvt_pk_bf16_f32 v193, v174, v175
    v_mul_f32 v178, v180, v178
    v_mul_f32 v179, v180, v179
    v_cvt_pk_bf16_f32 v194, v176, v177
    v_cvt_pk_bf16_f32 v195, v178, v179
    s_waitcnt vmcnt(9)
    v_bitop3_b32 v9, v53, v58, s49 bitop3:0x7e
    v_cmp_ne_u32 vcc, 0, v9
    s_nop 1
    s_cbranch_vccnz L_cold14
L_cold14_r:
    v_mfma_f32_32x32x16_bf16 v[172:187], v[54:57], a[140:143], 0
    buffer_load_dwordx4 a[156:159], v23, s[36:39], s97 offen offset:2048 sc1
    buffer_load_dwordx4 v[84:87], v18, s[36:39], s10 offen offset:1152 sc1
    buffer_load_dwordx3 v[88:90], v19, s[36:39], s10 offen offset:1152 sc1
    v_add_f32 v164, 0x358637bd, v164
    v_rcp_f32 v164, v164
    v_mfma_f32_32x32x16_bf16 v[92:107], a[200:203], v[192:195], v[92:107]
    v_mul_f32 v156, v164, v156
    v_mul_f32 v157, v164, v157
    v_mul_f32 v158, v164, v158
    v_mul_f32 v159, v164, v159
    v_cvt_pk_bf16_f32 v188, v156, v157
    v_mul_f32 v160, v164, v160
    ds_read_b64_tr_b16 a[52:53], v254 offset:6144
    v_mfma_f32_32x32x16_bf16 v[108:123], a[204:207], v[192:195], v[108:123]
    v_mul_f32 v161, v164, v161
    v_cvt_pk_bf16_f32 v189, v158, v159
    v_mul_f32 v162, v164, v162
    v_mul_f32 v163, v164, v163
    v_cvt_pk_bf16_f32 v190, v160, v161
    v_cvt_pk_bf16_f32 v191, v162, v163
    s_waitcnt vmcnt(9)
    v_bitop3_b32 v9, v61, v66, s49 bitop3:0x7e
    v_cmp_ne_u32 vcc, 0, v9
    s_nop 1
    s_cbranch_vccnz L_cold15
L_cold15_r:
    v_mfma_f32_32x32x16_bf16 v[156:171], v[62:65], a[144:147], 0
    v_add_f32 v180, 0x358637bd, v180
    v_rcp_f32 v180, v180
    ds_read_b64_tr_b16 a[56:57], v255 offset:0
    ds_read_b64_tr_b16 a[50:51], v254 offset:768
    ds_read_b64_tr_b16 a[54:55], v254 offset:6912
    v_mfma_f32_32x32x16_bf16 v[92:107], a[208:211], v[188:191], v[92:107]
    v_mul_f32 v172, v180, v172
    v_mul_f32 v173, v180, v173
    v_mul_f32 v174, v180, v174
    v_mul_f32 v175, v180, v175
    v_cvt_pk_bf16_f32 v192, v172, v173
    v_mul_f32 v176, v180, v176
    ds_read_b64_tr_b16 a[58:59], v255 offset:768
    v_mfma_f32_32x32x16_bf16 v[108:123], a[212:215], v[188:191], v[108:123]
    v_mul_f32 v177, v180, v177
    v_cvt_pk_bf16_f32 v193, v174, v175
    v_mul_f32 v178, v180, v178
    v_mul_f32 v179, v180, v179
    v_cvt_pk_bf16_f32 v194, v176, v177
    v_cvt_pk_bf16_f32 v195, v178, v179
    s_waitcnt vmcnt(6)
    v_bitop3_b32 v9, v69, v74, s49 bitop3:0x7e
    v_cmp_ne_u32 vcc, 0, v9
    s_nop 1
    s_cbranch_vccnz L_cold16
L_cold16_r:
    v_mfma_f32_32x32x16_bf16 v[172:187], v[70:73], a[148:151], 0
    v_add_f32 v164, 0x358637bd, v164
    v_rcp_f32 v164, v164
    ds_read_b64_tr_b16 a[60:61], v227 offset:49152
    ds_read_b64_tr_b16 a[64:65], v227 offset:55296
    ds_read_b64_tr_b16 a[68:69], v228 offset:49152
    ds_read_b64_tr_b16 a[62:63], v227 offset:49920
    v_mfma_f32_32x32x16_bf16 v[92:107], a[216:219], v[192:195], v[92:107]
    v_mul_f32 v156, v164, v156
    v_mul_f32 v157, v164, v157
    v_mul_f32 v158, v164, v158
    v_mul_f32 v159, v164, v159
    v_cvt_pk_bf16_f32 v188, v156, v157
    v_mul_f32 v160, v164, v160
    s_add_u32 s97, s14, 0
    buffer_load_dwordx4 a[160:163], v23, s[36:39], s97 offen offset:1024 sc1
    v_mfma_f32_32x32x16_bf16 v[108:123], a[220:223], v[192:195], v[108:123]
    v_mul_f32 v161, v164, v161
    v_cvt_pk_bf16_f32 v189, v158, v159
    v_mul_f32 v162, v164, v162
    v_mul_f32 v163, v164, v163
    v_cvt_pk_bf16_f32 v190, v160, v161
    v_cvt_pk_bf16_f32 v191, v162, v163
    s_waitcnt vmcnt(4)
    v_bitop3_b32 v9, v77, v82, s49 bitop3:0x7e
    v_cmp_ne_u32 vcc, 0, v9
    s_nop 1
    s_cbranch_vccnz L_cold17
L_cold17_r:
    v_mfma_f32_32x32x16_bf16 v[156:171], v[78:81], a[152:155], 0
    v_add_f32 v180, 0x358637bd, v180
    v_rcp_f32 v180, v180
    buffer_load_dwordx4 a[164:167], v23, s[36:39], s97 offen offset:3072 sc1
    s_add_u32 s97, s14, 4096
    buffer_load_dwordx4 a[168:171], v23, s[36:39], s97 offen offset:1024 sc1
    v_mfma_f32_32x32x16_bf16 v[92:107], a[224:227], v[188:191], v[92:107]
    v_mul_f32 v172, v180, v172
    v_mul_f32 v173, v180, v173
    v_mul_f32 v174, v180, v174
    v_mul_f32 v175, v180, v175
    v_cvt_pk_bf16_f32 v192, v172, v173
    v_mul_f32 v176, v180, v176
    ds_read_b64_tr_b16 a[66:67], v227 offset:56064
    v_mfma_f32_32x32x16_bf16 v[108:123], a[228:231], v[188:191], v[108:123]
    v_mul_f32 v177, v180, v177
    v_cvt_pk_bf16_f32 v193, v174, v175
    v_mul_f32 v178, v180, v178
    v_mul_f32 v179, v180, v179
    v_cvt_pk_bf16_f32 v194, v176, v177
    v_cvt_pk_bf16_f32 v195, v178, v179
    s_waitcnt vmcnt(3)
    v_bitop3_b32 v9, v85, v90, s49 bitop3:0x7e
    v_cmp_ne_u32 vcc, 0, v9
    s_nop 1
    s_cbranch_vccnz L_cold18
L_cold18_r:
    v_mfma_f32_32x32x16_bf16 v[172:187], v[86:89], a[156:159], 0
    v_add_f32 v164, 0x358637bd, v164
    v_rcp_f32 v164, v164
    buffer_load_dwordx4 a[172:175], v23, s[36:39], s97 offen offset:3072 sc1
    s_add_u32 s97, s14, 8192
    buffer_load_dwordx4 a[176:179], v23, s[36:39], s97 offen offset:1024 sc1
    v_mfma_f32_32x32x16_bf16 v[92:107], a[232:235], v[192:195], v[92:107]
    v_mul_f32 v156, v164, v156
    v_mul_f32 v157, v164, v157
    v_mul_f32 v158, v164, v158
    v_mul_f32 v159, v164, v159
    v_cvt_pk_bf16_f32 v188, v156, v157
    v_mul_f32 v160, v164, v160
    ds_read_b64_tr_b16 a[70:71], v228 offset:49920
    v_mfma_f32_32x32x16_bf16 v[108:123], a[236:239], v[192:195], v[108:123]
    v_mul_f32 v161, v164, v161
    v_cvt_pk_bf16_f32 v189, v158, v159
    v_mul_f32 v162, v164, v162
    v_mul_f32 v163, v164, v163
    v_cvt_pk_bf16_f32 v190, v160, v161
    v_cvt_pk_bf16_f32 v191, v162, v163
    buffer_load_dwordx4 a[180:183], v23, s[36:39], s97 offen offset:3072 sc1
    s_nop 0
    v_mfma_f32_32x32x16_bf16 v[92:107], a[240:243], v[188:191], v[92:107]
    v_add_f32 v180, 0x358637bd, v180
    v_rcp_f32 v180, v180
    s_nop 0
    v_mul_f32 v172, v180, v172
    v_mul_f32 v173, v180, v173
    v_mul_f32 v174, v180, v174
    v_mul_f32 v175, v180, v175
    v_cvt_pk_bf16_f32 v192, v172, v173
    v_mfma_f32_32x32x16_bf16 v[108:123], a[244:247], v[188:191], v[108:123]
    v_mul_f32 v176, v180, v176
    v_mul_f32 v177, v180, v177
    v_cvt_pk_bf16_f32 v193, v174, v175
    v_mul_f32 v178, v180, v178
    v_mul_f32 v179, v180, v179
    v_cvt_pk_bf16_f32 v194, v176, v177
    v_cvt_pk_bf16_f32 v195, v178, v179
    s_nop 1
    v_mfma_f32_32x32x16_bf16 v[92:107], a[248:251], v[192:195], v[92:107]
    s_add_u32 s97, s14, 12288
    buffer_load_dwordx4 a[184:187], v23, s[36:39], s97 offen offset:1024 sc1
    buffer_load_dwordx4 a[188:191], v23, s[36:39], s97 offen offset:3072 sc1
    v_mfma_f32_32x32x16_bf16 v[108:123], a[252:255], v[192:195], v[108:123]
    s_nop 7
    ds_write_b128 v234, v[92:95] offset:0
    s_waitcnt lgkmcnt(1)
    buffer_store_dwordx4 v[200:203], v252, s[36:39], s98 offen offset:0 sc1
    ds_write_b128 v12, v[96:99] offset:0
    ds_write_b128 v13, v[100:103] offset:0
    buffer_store_dwordx4 v[204:207], v252, s[36:39], s98 offen offset:2048 sc1
    ds_write_b128 v14, v[104:107] offset:0
    s_add_u32 s96, s1, 6
    s_and_b32 s96, s96, 15
    s_add_u32 m0, s6, 77824
    s_mul_i32 s96, s96, 88064
    buffer_load_dwordx4 v224, s[20:23], s96 offen  lds
    ds_write_b128 v234, v[108:111] offset:128
    ds_write_b128 v12, v[112:115] offset:128
    buffer_load_dwordx4 v225, s[20:23], s96 offen offset:1024  lds
    ds_write_b128 v13, v[116:119] offset:128
    buffer_load_dwordx4 v226, s[20:23], s96 offen offset:2048  lds
    ds_write_b128 v14, v[120:123] offset:128
    s_waitcnt lgkmcnt(0)
    s_barrier
    ds_read_b128 v[124:127], v235 offset:0
    ds_read_b128 v[128:131], v15 offset:0
    ds_read_b128 v[132:135], v235 offset:8192
    ds_read_b128 v[136:139], v15 offset:8192
    s_add_u32 s96, s1, 7
    s_and_b32 s96, s96, 15
    s_add_u32 m0, s6, 65536
    s_mul_i32 s96, s96, 88064
    buffer_load_dwordx4 v224, s[20:23], s96 offen  lds
    ds_read_b128 v[140:143], v235 offset:16384
    ds_read_b128 v[144:147], v15 offset:16384
    ds_read_b128 v[148:151], v235 offset:24576
    ds_read_b128 v[152:155], v15 offset:24576
    v_lshlrev_b32 v156, 16, v240
    v_and_b32 v157, 0xffff0000, v240
    v_lshlrev_b32 v158, 16, v241
    v_and_b32 v159, 0xffff0000, v241
    v_lshlrev_b32 v160, 16, v242
    v_and_b32 v161, 0xffff0000, v242
    v_lshlrev_b32 v162, 16, v243
    buffer_load_dwordx4 v225, s[20:23], s96 offen offset:1024  lds
    v_and_b32 v163, 0xffff0000, v243
    s_waitcnt lgkmcnt(5)
    v_pk_add_f32 v[124:125], v[124:125], v[132:133]
    v_pk_add_f32 v[126:127], v[126:127], v[134:135]
    s_waitcnt lgkmcnt(4)
    v_pk_add_f32 v[128:129], v[128:129], v[136:137]
    v_pk_add_f32 v[130:131], v[130:131], v[138:139]
    s_waitcnt lgkmcnt(1)
    v_pk_add_f32 v[140:141], v[140:141], v[148:149]
    v_pk_add_f32 v[142:143], v[142:143], v[150:151]
    s_waitcnt lgkmcnt(0)
    v_pk_add_f32 v[144:145], v[144:145], v[152:153]
    v_pk_add_f32 v[146:147], v[146:147], v[154:155]
    v_pk_add_f32 v[124:125], v[124:125], v[140:141]
    v_pk_add_f32 v[126:127], v[126:127], v[142:143]
    buffer_load_dwordx4 v226, s[20:23], s96 offen offset:2048  lds
    v_pk_add_f32 v[128:129], v[128:129], v[144:145]
    v_pk_add_f32 v[130:131], v[130:131], v[146:147]
    v_pk_add_f32 v[124:125], v[124:125], v[156:157]
    v_pk_add_f32 v[126:127], v[126:127], v[158:159]
    v_pk_add_f32 v[128:129], v[128:129], v[160:161]
    v_pk_add_f32 v[130:131], v[130:131], v[162:163]
    v_cvt_pk_bf16_f32 v240, v124, v125
    v_cvt_pk_bf16_f32 v241, v126, v127
    v_cvt_pk_bf16_f32 v242, v128, v129
    v_cvt_pk_bf16_f32 v243, v130, v131
    buffer_store_dwordx4 v[240:243], v16, s[36:39], s12 offen sc1
    s_add_u32 s96, s1, 8
    s_and_b32 s96, s96, 15
    s_add_u32 m0, s6, 53248
    s_mul_i32 s96, s96, 88064
    buffer_load_dwordx4 v224, s[20:23], s96 offen  lds
    v_dot2_f32_bf16 v196, v240, v24, 0
    v_dot2_f32_bf16 v197, v240, v240, 0
    v_dot2_f32_bf16 v196, v241, v24, v196
    v_dot2_f32_bf16 v197, v241, v241, v197
    v_dot2_f32_bf16 v196, v242, v24, v196
    v_dot2_f32_bf16 v197, v242, v242, v197
    v_dot2_f32_bf16 v196, v243, v24, v196
    v_dot2_f32_bf16 v197, v243, v243, v197
    s_nop 2
    buffer_load_dwordx4 v225, s[20:23], s96 offen offset:1024  lds
    v_add_f32_dpp v196, v196, v196 quad_perm:[1,0,3,2] row_mask:0xf bank_mask:0xf
    v_add_f32_dpp v197, v197, v197 quad_perm:[1,0,3,2] row_mask:0xf bank_mask:0xf
    s_nop 0
    v_add_f32_dpp v196, v196, v196 quad_perm:[2,3,0,1] row_mask:0xf bank_mask:0xf
    v_add_f32_dpp v197, v197, v197 quad_perm:[2,3,0,1] row_mask:0xf bank_mask:0xf
    s_nop 0
    v_add_f32_dpp v196, v196, v196 row_half_mirror row_mask:0xf bank_mask:0xf
    v_add_f32_dpp v197, v197, v197 row_half_mirror row_mask:0xf bank_mask:0xf
    buffer_store_dwordx2 v[196:197], v17, s[36:39], s13 offen offset:0 sc1
    s_getpc_b64 s[62:63]
    v_lshrrev_b32 v8, 5, v0
    v_min_u32 v8, 4, v8
    s_lshl_b32 s54, s41, 7
    v_lshl_add_u32 v8, v8, 12, s54
    global_load_dword v220, v8, s[62:63]
    s_waitcnt vmcnt(20)
    v_mfma_f32_32x32x16_bf16 v[156:171], v[30:33], a[160:163], 0
    s_add_u32 s96, s1, 8
    s_and_b32 s96, s96, 15
    s_add_u32 m0, s6, 53248
    s_mul_i32 s96, s96, 88064
    buffer_load_dwordx4 v226, s[20:23], s96 offen offset:2048  lds
    s_add_u32 s96, s1, 9
    s_waitcnt vmcnt(20)
    v_mfma_f32_32x32x16_bf16 v[172:187], v[38:41], a[164:167], 0
    s_nop 3
    v_add_f32 v164, 0x358637bd, v164
    v_rcp_f32 v164, v164
    s_nop 0
    v_mul_f32 v156, v164, v156
    v_mul_f32 v157, v164, v157
    v_mul_f32 v158, v164, v158
    v_mul_f32 v159, v164, v159
    v_cvt_pk_bf16_f32 v188, v156, v157
    v_mul_f32 v160, v164, v160
    v_mul_f32 v161, v164, v161
    v_cvt_pk_bf16_f32 v189, v158, v159
    v_mul_f32 v162, v164, v162
    v_mul_f32 v163, v164, v163
    v_cvt_pk_bf16_f32 v190, v160, v161
    v_cvt_pk_bf16_f32 v191, v162, v163
    s_waitcnt vmcnt(19)
    v_mfma_f32_32x32x16_bf16 v[156:171], v[46:49], a[168:171], 0
    v_add_f32 v180, 0x358637bd, v180
    v_rcp_f32 v180, v180
    s_and_b32 s96, s96, 15
    s_add_u32 m0, s6, 40960
    s_mul_i32 s96, s96, 88064
    buffer_load_dwordx4 v224, s[20:23], s96 offen  lds
    v_mfma_f32_32x32x16_bf16 v[92:107], a[192:195], v[188:191], 0
    v_mul_f32 v172, v180, v172
    v_mul_f32 v173, v180, v173
    v_mul_f32 v174, v180, v174
    v_mul_f32 v175, v180, v175
    v_cvt_pk_bf16_f32 v192, v172, v173
    v_mul_f32 v176, v180, v176
    v_mfma_f32_32x32x16_bf16 v[108:123], a[196:199], v[188:191], 0
    v_mul_f32 v177, v180, v177
    v_cvt_pk_bf16_f32 v193, v174, v175
    v_mul_f32 v178, v180, v178
    v_mul_f32 v179, v180, v179
    v_cvt_pk_bf16_f32 v194, v176, v177
    v_cvt_pk_bf16_f32 v195, v178, v179
    s_waitcnt vmcnt(19)
    v_mfma_f32_32x32x16_bf16 v[172:187], v[54:57], a[172:175], 0
    v_add_f32 v164, 0x358637bd, v164
    v_rcp_f32 v164, v164
    buffer_load_dwordx4 v225, s[20:23], s96 offen offset:1024  lds
    v_mfma_f32_32x32x16_bf16 v[92:107], a[200:203], v[192:195], v[92:107]
    v_mul_f32 v156, v164, v156
    v_mul_f32 v157, v164, v157
    v_mul_f32 v158, v164, v158
    v_mul_f32 v159, v164, v159
    v_cvt_pk_bf16_f32 v188, v156, v157
    v_mul_f32 v160, v164, v160
    v_mfma_f32_32x32x16_bf16 v[108:123], a[204:207], v[192:195], v[108:123]
    v_mul_f32 v161, v164, v161
    v_cvt_pk_bf16_f32 v189, v158, v159
    v_mul_f32 v162, v164, v162
    v_mul_f32 v163, v164, v163
    v_cvt_pk_bf16_f32 v190, v160, v161
    v_cvt_pk_bf16_f32 v191, v162, v163
    s_waitcnt vmcnt(19)
    v_mfma_f32_32x32x16_bf16 v[156:171], v[62:65], a[176:179], 0
    v_add_f32 v180, 0x358637bd, v180
    v_rcp_f32 v180, v180
    buffer_load_dwordx4 v226, s[20:23], s96 offen offset:2048  lds
    s_add_u32 s96, s1, 10
    s_and_b32 s96, s96, 15
    v_mfma_f32_32x32x16_bf16 v[92:107], a[208:211], v[188:191], v[92:107]
    v_mul_f32 v172, v180, v172
    v_mul_f32 v173, v180, v173
    v_mul_f32 v174, v180, v174
    v_mul_f32 v175, v180, v175
    v_cvt_pk_bf16_f32 v192, v172, v173
    v_mul_f32 v176, v180, v176
    v_mfma_f32_32x32x16_bf16 v[108:123], a[212:215], v[188:191], v[108:123]
    v_mul_f32 v177, v180, v177
    v_cvt_pk_bf16_f32 v193, v174, v175
    v_mul_f32 v178, v180, v178
    v_mul_f32 v179, v180, v179
    v_cvt_pk_bf16_f32 v194, v176, v177
    v_cvt_pk_bf16_f32 v195, v178, v179
    s_waitcnt vmcnt(19)
    v_mfma_f32_32x32x16_bf16 v[172:187], v[70:73], a[180:183], 0
    v_add_f32 v164, 0x358637bd, v164
    v_rcp_f32 v164, v164
    s_add_u32 m0, s6, 151552
    s_mul_i32 s96, s96, 88064
    buffer_load_dwordx4 v224, s[20:23], s96 offen  lds
    v_mfma_f32_32x32x16_bf16 v[92:107], a[216:219], v[192:195], v[92:107]
    v_mul_f32 v156, v164, v156
    v_mul_f32 v157, v164, v157
    v_mul_f32 v158, v164, v158
    v_mul_f32 v159, v164, v159
    v_cvt_pk_bf16_f32 v188, v156, v157
    v_mul_f32 v160, v164, v160
    v_mfma_f32_32x32x16_bf16 v[108:123], a[220:223], v[192:195], v[108:123]
    v_mul_f32 v161, v164, v161
    v_cvt_pk_bf16_f32 v189, v158, v159
    v_mul_f32 v162, v164, v162
    v_mul_f32 v163, v164, v163
    v_cvt_pk_bf16_f32 v190, v160, v161
    v_cvt_pk_bf16_f32 v191, v162, v163
    s_waitcnt vmcnt(19)
    v_mfma_f32_32x32x16_bf16 v[156:171], v[78:81], a[184:187], 0
    v_add_f32 v180, 0x358637bd, v180
    v_rcp_f32 v180, v180
    buffer_load_dwordx4 v225, s[20:23], s96 offen offset:1024  lds
    v_mfma_f32_32x32x16_bf16 v[92:107], a[224:227], v[188:191], v[92:107]
    v_mul_f32 v172, v180, v172
    v_mul_f32 v173, v180, v173
    v_mul_f32 v174, v180, v174
    v_mul_f32 v175, v180, v175
    v_cvt_pk_bf16_f32 v192, v172, v173
    v_mul_f32 v176, v180, v176
    v_mfma_f32_32x32x16_bf16 v[108:123], a[228:231], v[188:191], v[108:123]
    v_mul_f32 v177, v180, v177
    v_cvt_pk_bf16_f32 v193, v174, v175
    v_mul_f32 v178, v180, v178
    v_mul_f32 v179, v180, v179
    v_cvt_pk_bf16_f32 v194, v176, v177
    v_cvt_pk_bf16_f32 v195, v178, v179
    s_waitcnt vmcnt(19)
    v_mfma_f32_32x32x16_bf16 v[172:187], v[86:89], a[188:191], 0
    v_add_f32 v164, 0x358637bd, v164
    v_rcp_f32 v164, v164
    buffer_load_dwordx4 v226, s[20:23], s96 offen offset:2048  lds
    s_add_u32 s96, s1, 11
    s_and_b32 s96, s96, 15
    v_mfma_f32_32x32x16_bf16 v[92:107], a[232:235], v[192:195], v[92:107]
    v_mul_f32 v156, v164, v156
    v_mul_f32 v157, v164, v157
    v_mul_f32 v158, v164, v158
    v_mul_f32 v159, v164, v159
    v_cvt_pk_bf16_f32 v188, v156, v157
    v_mul_f32 v160, v164, v160
    v_mfma_f32_32x32x16_bf16 v[108:123], a[236:239], v[192:195], v[108:123]
    v_mul_f32 v161, v164, v161
    v_cvt_pk_bf16_f32 v189, v158, v159
    v_mul_f32 v162, v164, v162
    v_mul_f32 v163, v164, v163
    v_cvt_pk_bf16_f32 v190, v160, v161
    v_cvt_pk_bf16_f32 v191, v162, v163
    s_nop 1
    v_mfma_f32_32x32x16_bf16 v[92:107], a[240:243], v[188:191], v[92:107]
    v_add_f32 v180, 0x358637bd, v180
    v_rcp_f32 v180, v180
    s_nop 0
    v_mul_f32 v172, v180, v172
    v_mul_f32 v173, v180, v173
    v_mul_f32 v174, v180, v174
    v_mul_f32 v175, v180, v175
    v_cvt_pk_bf16_f32 v192, v172, v173
    v_mfma_f32_32x32x16_bf16 v[108:123], a[244:247], v[188:191], v[108:123]
    v_mul_f32 v176, v180, v176
    v_mul_f32 v177, v180, v177
    v_cvt_pk_bf16_f32 v193, v174, v175
    v_mul_f32 v178, v180, v178
    v_mul_f32 v179, v180, v179
    v_cvt_pk_bf16_f32 v194, v176, v177
    v_cvt_pk_bf16_f32 v195, v178, v179
    s_nop 1
    v_mfma_f32_32x32x16_bf16 v[92:107], a[248:251], v[192:195], v[92:107]
    s_add_u32 m0, s6, 139264
    s_mul_i32 s96, s96, 88064
    buffer_load_dwordx4 v224, s[20:23], s96 offen  lds
    v_mfma_f32_32x32x16_bf16 v[108:123], a[252:255], v[192:195], v[108:123]
    s_waitcnt vmcnt(9)
    s_waitcnt lgkmcnt(0)
    s_barrier
    s_lshl_b32 s98, s27, 8
    s_add_u32 s98, s98, 4096
    v_mov_b32 v238, 1
    buffer_atomic_add v238, v222, s[36:39], s98 offen sc1
    s_lshl_b32 s98, s45, 8
    s_add_u32 s98, s98, 24576
    v_mov_b32 v238, 1
    buffer_atomic_add v238, v222, s[36:39], s98 offen sc1
    s_lshl_b32 s18, s46, 8
    s_add_u32 s18, s18, 4096
    s_lshl_b32 s19, s45, 8
    s_add_u32 s19, s19, 24576
    ds_write_b128 v234, v[92:95] offset:0
    s_add_u32 s96, s1, 11
    s_and_b32 s96, s96, 15
    s_add_u32 m0, s6, 139264
    s_mul_i32 s96, s96, 88064
    buffer_load_dwordx4 v225, s[20:23], s96 offen offset:1024  lds
    ds_write_b128 v12, v[96:99] offset:0
    ds_write_b128 v13, v[100:103] offset:0
    buffer_load_dwordx4 v226, s[20:23], s96 offen offset:2048  lds
    ds_write_b128 v14, v[104:107] offset:0
    ds_write_b128 v234, v[108:111] offset:128
    s_add_u32 s96, s1, 12
    s_and_b32 s96, s96, 15
    s_add_u32 m0, s6, 126976
    s_mul_i32 s96, s96, 88064
    buffer_load_dwordx4 v224, s[20:23], s96 offen  lds
    ds_write_b128 v12, v[112:115] offset:128
    ds_write_b128 v13, v[116:119] offset:128
    buffer_load_dwordx4 v225, s[20:23], s96 offen offset:1024  lds
    ds_write_b128 v14, v[120:123] offset:128
    s_waitcnt lgkmcnt(0)
    s_barrier
    ds_read_b128 v[124:127], v235 offset:0
    ds_read_b128 v[128:131], v15 offset:0
    ds_read_b128 v[132:135], v235 offset:8192
    s_add_u32 s96, s1, 12
    s_and_b32 s96, s96, 15
    s_add_u32 m0, s6, 126976
    s_mul_i32 s96, s96, 88064
    buffer_load_dwordx4 v226, s[20:23], s96 offen offset:2048  lds
    ds_read_b128 v[136:139], v15 offset:8192
    ds_read_b128 v[140:143], v235 offset:16384
    ds_read_b128 v[144:147], v15 offset:16384
    ds_read_b128 v[148:151], v235 offset:24576
    ds_read_b128 v[152:155], v15 offset:24576
    v_lshlrev_b32 v156, 16, v244
    v_and_b32 v157, 0xffff0000, v244
    v_lshlrev_b32 v158, 16, v245
    v_and_b32 v159, 0xffff0000, v245
    v_lshlrev_b32 v160, 16, v246
    s_add_u32 s96, s1, 13
    s_and_b32 s96, s96, 15
    s_add_u32 m0, s6, 114688
    s_mul_i32 s96, s96, 88064
    buffer_load_dwordx4 v224, s[20:23], s96 offen  lds
    v_and_b32 v161, 0xffff0000, v246
    v_lshlrev_b32 v162, 16, v247
    v_and_b32 v163, 0xffff0000, v247
    s_waitcnt lgkmcnt(5)
    v_pk_add_f32 v[124:125], v[124:125], v[132:133]
    v_pk_add_f32 v[126:127], v[126:127], v[134:135]
    s_waitcnt lgkmcnt(4)
    v_pk_add_f32 v[128:129], v[128:129], v[136:137]
    v_pk_add_f32 v[130:131], v[130:131], v[138:139]
    s_waitcnt lgkmcnt(1)
    v_pk_add_f32 v[140:141], v[140:141], v[148:149]
    v_pk_add_f32 v[142:143], v[142:143], v[150:151]
    s_waitcnt lgkmcnt(0)
    v_pk_add_f32 v[144:145], v[144:145], v[152:153]
    buffer_load_dwordx4 v225, s[20:23], s96 offen offset:1024  lds
    v_pk_add_f32 v[146:147], v[146:147], v[154:155]
    v_pk_add_f32 v[124:125], v[124:125], v[140:141]
    v_pk_add_f32 v[126:127], v[126:127], v[142:143]
    v_pk_add_f32 v[128:129], v[128:129], v[144:145]
    v_pk_add_f32 v[130:131], v[130:131], v[146:147]
    v_pk_add_f32 v[124:125], v[124:125], v[156:157]
    v_pk_add_f32 v[126:127], v[126:127], v[158:159]
    v_pk_add_f32 v[128:129], v[128:129], v[160:161]
    v_pk_add_f32 v[130:131], v[130:131], v[162:163]
    v_cvt_pk_bf16_f32 v244, v124, v125
    buffer_load_dwordx4 v226, s[20:23], s96 offen offset:2048  lds
    v_cvt_pk_bf16_f32 v245, v126, v127
    v_cvt_pk_bf16_f32 v246, v128, v129
    v_cvt_pk_bf16_f32 v247, v130, v131
    s_add_u32 s12, s12, 65536
    buffer_store_dwordx4 v[244:247], v16, s[36:39], s12 offen sc1
    v_dot2_f32_bf16 v198, v244, v24, 0
    v_dot2_f32_bf16 v199, v244, v244, 0
    s_cmp_lg_u32 s48, 0
    s_cbranch_scc1 L_lk19
    s_mov_b32 s62, 0
    s_atomic_or s62, s[36:37], s18 glc
L_lk19:
    v_dot2_f32_bf16 v198, v245, v24, v198
    v_dot2_f32_bf16 v199, v245, v245, v199
    v_dot2_f32_bf16 v198, v246, v24, v198
    v_dot2_f32_bf16 v199, v246, v246, v199
    v_dot2_f32_bf16 v198, v247, v24, v198
    v_dot2_f32_bf16 v199, v247, v247, v199
    s_nop 2
    v_add_f32_dpp v198, v198, v198 quad_perm:[1,0,3,2] row_mask:0xf bank_mask:0xf
    v_add_f32_dpp v199, v199, v199 quad_perm:[1,0,3,2] row_mask:0xf bank_mask:0xf
    s_nop 0
    v_add_f32_dpp v198, v198, v198 quad_perm:[2,3,0,1] row_mask:0xf bank_mask:0xf
    v_add_f32_dpp v199, v199, v199 quad_perm:[2,3,0,1] row_mask:0xf bank_mask:0xf
    s_nop 0
    v_add_f32_dpp v198, v198, v198 row_half_mirror row_mask:0xf bank_mask:0xf
    v_add_f32_dpp v199, v199, v199 row_half_mirror row_mask:0xf bank_mask:0xf
    buffer_store_dwordx2 v[198:199], v17, s[36:39], s13 offen offset:512 sc1
    v_mfma_f32_16x16x32_bf16 v[208:211], a[0:3], v[24:27], 0
    s_add_u32 s96, s1, 14
    s_and_b32 s96, s96, 15
    s_add_u32 m0, s6, 102400
    s_mul_i32 s96, s96, 88064
    buffer_load_dwordx4 v224, s[20:23], s96 offen  lds
    v_mfma_f32_16x16x32_bf16 v[212:215], a[4:7], v[24:27], 0
    ds_read_b64_tr_b16 a[72:73], v227 offset:36864
    v_mfma_f32_16x16x32_bf16 v[216:219], a[8:11], v[24:27], 0
    ds_read_b64_tr_b16 a[76:77], v227 offset:43008
    v_mfma_f32_16x16x32_bf16 v[208:211], a[12:15], v[24:27], v[208:211]
    buffer_load_dwordx4 v225, s[20:23], s96 offen offset:1024  lds
    ds_read_b64_tr_b16 a[80:81], v228 offset:36864
    v_mfma_f32_16x16x32_bf16 v[212:215], a[16:19], v[24:27], v[212:215]
    ds_read_b64_tr_b16 a[74:75], v227 offset:37632
    v_mfma_f32_16x16x32_bf16 v[216:219], a[20:23], v[24:27], v[216:219]
    ds_read_b64_tr_b16 a[78:79], v227 offset:43776
    v_mfma_f32_16x16x32_bf16 v[208:211], a[24:27], v[24:27], v[208:211]
    buffer_load_dwordx4 v226, s[20:23], s96 offen offset:2048  lds
    s_add_u32 s96, s1, 15
    v_mfma_f32_16x16x32_bf16 v[212:215], a[28:31], v[24:27], v[212:215]
    s_and_b32 s96, s96, 15
    s_add_u32 m0, s6, 90112
    v_mfma_f32_16x16x32_bf16 v[216:219], a[32:35], v[24:27], v[216:219]
    s_mul_i32 s96, s96, 88064
    ds_read_b64_tr_b16 a[82:83], v228 offset:37632
    v_mfma_f32_16x16x32_bf16 v[208:211], a[36:39], v[24:27], v[208:211]
    buffer_load_dwordx4 v224, s[20:23], s96 offen  lds
    ds_read_b64_tr_b16 a[84:85], v227 offset:24576
    v_mfma_f32_16x16x32_bf16 v[212:215], a[40:43], v[24:27], v[212:215]
    ds_read_b64_tr_b16 a[88:89], v227 offset:30720
    v_mfma_f32_16x16x32_bf16 v[216:219], a[44:47], v[24:27], v[216:219]
    ds_read_b64_tr_b16 a[92:93], v228 offset:24576
    v_mfma_f32_16x16x32_bf16 v[208:211], a[48:51], v[24:27], v[208:211]
    buffer_load_dwordx4 v225, s[20:23], s96 offen offset:1024  lds
    ds_read_b64_tr_b16 a[86:87], v227 offset:25344
    v_mfma_f32_16x16x32_bf16 v[212:215], a[52:55], v[24:27], v[212:215]
    ds_read_b64_tr_b16 a[90:91], v227 offset:31488
    v_mfma_f32_16x16x32_bf16 v[216:219], a[56:59], v[24:27], v[216:219]
    ds_read_b64_tr_b16 a[94:95], v228 offset:25344
    v_mfma_f32_16x16x32_bf16 v[208:211], a[60:63], v[24:27], v[208:211]
    buffer_load_dwordx4 v226, s[20:23], s96 offen offset:2048  lds
    v_mfma_f32_16x16x32_bf16 v[212:215], a[64:67], v[24:27], v[212:215]
    v_mfma_f32_16x16x32_bf16 v[216:219], a[68:71], v[24:27], v[216:219]
    s_or_b32 s54, s2, s48
    s_cmp_lg_u32 s54, 0
    s_cbranch_scc1 L_skip20
    s_atomic_swap s49, s[36:37], 0
L_skip20:
    s_waitcnt lgkmcnt(0)
    s_sub_u32 s62, s62, s49
    s_xor_b32 s62, s62, 16
    s_and_b32 s62, s62, s101
    s_cbranch_scc1 L_cold21
L_cold21_r:
    s_waitcnt vmcnt(14)
    s_waitcnt lgkmcnt(0)
    s_barrier
    v_mfma_f32_16x16x32_bf16 v[208:211], a[72:75], v[24:27], v[208:211]
    s_add_u32 m0, s60, 0
    s_add_u32 s96, s3, 0
    buffer_load_dwordx4 v23, s[36:39], s96 offen sc1 lds
    ds_read_b64_tr_b16 a[96:97], v227 offset:12288
    ds_read_b64_tr_b16 a[100:101], v227 offset:18432
    v_mfma_f32_16x16x32_bf16 v[212:215], a[76:79], v[24:27], v[212:215]
    ds_read_b64_tr_b16 a[104:105], v228 offset:12288
    ds_read_b64_tr_b16 a[98:99], v227 offset:13056
    ds_read_b64_tr_b16 a[102:103], v227 offset:19200
    ds_read_b64_tr_b16 a[106:107], v228 offset:13056
    ds_read_b64_tr_b16 a[108:109], v227 offset:0
    v_mfma_f32_16x16x32_bf16 v[216:219], a[80:83], v[24:27], v[216:219]
    buffer_load_dwordx4 v23, s[36:39], s96 offen offset:1024 sc1 lds
    ds_read_b64_tr_b16 a[112:113], v227 offset:6144
    s_branch L_pgo4
L_pg4:
    s_branch L_pgback1
L_pgo4:
    ds_read_b64_tr_b16 a[116:117], v228 offset:0
    ds_read_b64_tr_b16 a[110:111], v227 offset:768
    ds_read_b64_tr_b16 a[114:115], v227 offset:6912
    v_mfma_f32_16x16x32_bf16 v[208:211], a[84:87], v[24:27], v[208:211]
    ds_read_b64_tr_b16 a[118:119], v228 offset:768
    ds_read_b64_tr_b16 a[120:121], v254 offset:49152
    ds_read_b64_tr_b16 a[124:125], v254 offset:55296
    ds_read_b64_tr_b16 a[128:129], v255 offset:49152
    v_mfma_f32_16x16x32_bf16 v[212:215], a[88:91], v[24:27], v[212:215]
    ds_read_b64_tr_b16 a[122:123], v254 offset:49920
    ds_read_b64_tr_b16 a[126:127], v254 offset:56064
    ds_read_b64_tr_b16 a[130:131], v255 offset:49920
    ds_read_b64_tr_b16 a[132:133], v254 offset:36864
    ds_read_b64_tr_b16 a[136:137], v254 offset:43008
    v_mfma_f32_16x16x32_bf16 v[216:219], a[92:95], v[24:27], v[216:219]
    buffer_load_dwordx4 v23, s[36:39], s96 offen offset:2048 sc1 lds
    ds_read_b64_tr_b16 a[140:141], v255 offset:36864
    ds_read_b64_tr_b16 a[134:135], v254 offset:37632
    ds_read_b64_tr_b16 a[138:139], v254 offset:43776
    ds_read_b64_tr_b16 a[142:143], v255 offset:37632
    s_waitcnt lgkmcnt(15)
    v_mfma_f32_16x16x32_bf16 v[208:211], a[96:99], v[24:27], v[208:211]
    v_mfma_f32_16x16x32_bf16 v[212:215], a[100:103], v[24:27], v[212:215]
    buffer_load_dwordx4 v23, s[36:39], s96 offen offset:3072 sc1 lds
    v_mfma_f32_16x16x32_bf16 v[216:219], a[104:107], v[24:27], v[216:219]
    s_waitcnt lgkmcnt(14)
    v_mfma_f32_16x16x32_bf16 v[208:211], a[108:111], v[24:27], v[208:211]
    s_waitcnt lgkmcnt(13)
    v_mfma_f32_16x16x32_bf16 v[212:215], a[112:115], v[24:27], v[212:215]
    buffer_load_dwordx2 v[40:41], v7, s[36:39], s17 offen offset:0 sc1
    s_waitcnt lgkmcnt(12)
    v_mfma_f32_16x16x32_bf16 v[216:219], a[116:119], v[24:27], v[216:219]
    s_waitcnt lgkmcnt(8)
    v_mfma_f32_16x16x32_bf16 v[208:211], a[120:123], v[24:27], v[208:211]
    buffer_load_dwordx2 v[42:43], v7, s[36:39], s17 offen offset:1024 sc1
    v_mov_b32 v238, 0
    s_waitcnt lgkmcnt(7)
    v_mfma_f32_16x16x32_bf16 v[212:215], a[124:127], v[24:27], v[212:215]
    s_waitcnt lgkmcnt(5)
    v_mfma_f32_16x16x32_bf16 v[216:219], a[128:131], v[24:27], v[216:219]
    s_waitcnt lgkmcnt(2)
    v_mfma_f32_16x16x32_bf16 v[208:211], a[132:135], v[24:27], v[208:211]
    buffer_atomic_or v238, v222, s[36:39], s19 offen sc0 sc1
    s_waitcnt lgkmcnt(0)
    v_mfma_f32_16x16x32_bf16 v[212:215], a[136:139], v[24:27], v[212:215]
    v_mfma_f32_16x16x32_bf16 v[216:219], a[140:143], v[24:27], v[216:219]
    s_waitcnt vmcnt(13)
    s_waitcnt vmcnt(7)
    s_waitcnt lgkmcnt(0)
    s_barrier
    ds_read_b64_tr_b16 a[144:145], v254 offset:24576
    ds_read_b64_tr_b16 a[148:149], v254 offset:30720
    ds_read_b64_tr_b16 a[152:153], v255 offset:24576
    ds_read_b64_tr_b16 a[146:147], v254 offset:25344
    s_lshl_b32 s98, s27, 8
    s_add_u32 s98, s98, 8192
    v_mov_b32 v8, 1
    buffer_atomic_add v8, v222, s[36:39], s98 offen sc1
    ds_read_b64_tr_b16 a[150:151], v254 offset:31488
    ds_read_b64_tr_b16 a[154:155], v255 offset:25344
    ds_read_b64_tr_b16 a[156:157], v254 offset:12288
    ds_read_b64_tr_b16 a[160:161], v254 offset:18432
    ds_read_b64_tr_b16 a[164:165], v255 offset:12288
    ds_read_b64_tr_b16 a[158:159], v254 offset:13056
    ds_read_b64_tr_b16 a[162:163], v254 offset:19200
    ds_read_b64_tr_b16 a[166:167], v255 offset:13056
    ds_read_b64_tr_b16 a[168:169], v254 offset:0
    ds_read_b64_tr_b16 a[172:173], v254 offset:6144
    ds_read_b64_tr_b16 a[176:177], v255 offset:0
    ds_read_b64_tr_b16 a[170:171], v254 offset:768
    s_add_u32 m0, s60, 16384
    s_add_u32 s96, s3, 16384
    buffer_load_dwordx4 v23, s[36:39], s96 offen sc1 lds
    ds_read_b64_tr_b16 a[174:175], v254 offset:6912
    ds_read_b64_tr_b16 a[178:179], v255 offset:768
    ds_read_b64_tr_b16 a[180:181], v227 offset:49152
    ds_read_b64_tr_b16 a[184:185], v227 offset:55296
    ds_read_b64_tr_b16 a[188:189], v228 offset:49152
    ds_read_b64_tr_b16 a[182:183], v227 offset:49920
    ds_read_b64_tr_b16 a[186:187], v227 offset:56064
    ds_read_b64_tr_b16 a[190:191], v228 offset:49920
    s_waitcnt lgkmcnt(15)
    v_mfma_f32_16x16x32_bf16 v[208:211], a[144:147], v[24:27], v[208:211]
    buffer_load_dwordx4 v23, s[36:39], s96 offen offset:1024 sc1 lds
    v_mfma_f32_16x16x32_bf16 v[212:215], a[148:151], v[24:27], v[212:215]
    v_mfma_f32_16x16x32_bf16 v[216:219], a[152:155], v[24:27], v[216:219]
    s_waitcnt lgkmcnt(14)
    v_mfma_f32_16x16x32_bf16 v[208:211], a[156:159], v[24:27], v[208:211]
    s_waitcnt lgkmcnt(13)
    v_mfma_f32_16x16x32_bf16 v[212:215], a[160:163], v[24:27], v[212:215]
    buffer_load_dwordx4 v23, s[36:39], s96 offen offset:2048 sc1 lds
    s_waitcnt lgkmcnt(12)
    v_mfma_f32_16x16x32_bf16 v[216:219], a[164:167], v[24:27], v[216:219]
    s_waitcnt lgkmcnt(8)
    v_mfma_f32_16x16x32_bf16 v[208:211], a[168:171], v[24:27], v[208:211]
    s_waitcnt lgkmcnt(7)
    v_mfma_f32_16x16x32_bf16 v[212:215], a[172:175], v[24:27], v[212:215]
    s_waitcnt lgkmcnt(6)
    v_mfma_f32_16x16x32_bf16 v[216:219], a[176:179], v[24:27], v[216:219]
    buffer_load_dwordx4 v23, s[36:39], s96 offen offset:3072 sc1 lds
    s_waitcnt lgkmcnt(2)
    v_mfma_f32_16x16x32_bf16 v[208:211], a[180:183], v[24:27], v[208:211]
    s_waitcnt lgkmcnt(0)
    v_mfma_f32_16x16x32_bf16 v[212:215], a[184:187], v[24:27], v[212:215]
    v_mfma_f32_16x16x32_bf16 v[216:219], a[188:191], v[24:27], v[216:219]
    s_nop 7
    v_permlane16_swap_b32 v216, v218
    v_permlane16_swap_b32 v217, v219
    s_lshl_b32 s18, s46, 8
    s_add_u32 s18, s18, 8192
    s_lshl_b32 s8, s27, 8
    s_add_u32 s8, s8, 12288
    s_waitcnt vmcnt(8)
    s_waitcnt lgkmcnt(0)
    s_barrier
    ds_read_b128 v[72:75], v23 offset:0
    ds_read_b128 v[76:79], v23 offset:1024
    ds_read_b128 v[80:83], v23 offset:2048
    ds_read_b128 v[84:87], v23 offset:3072
    s_waitcnt lgkmcnt(3)
    v_mfma_f32_16x16x32_bf16 v[48:51], a[0:3], v[72:75], 0
    ds_read_b128 v[224:227], v23 offset:4096
    s_add_u32 m0, s60, 32768
    s_add_u32 s96, s3, 32768
    buffer_load_dwordx4 v23, s[36:39], s96 offen sc1 lds
    v_mfma_f32_16x16x32_bf16 v[52:55], a[4:7], v[72:75], 0
    v_mfma_f32_16x16x32_bf16 v[56:59], a[8:11], v[72:75], 0
    ds_read_b128 v[228:231], v23 offset:5120
    s_waitcnt lgkmcnt(4)
    v_mfma_f32_16x16x32_bf16 v[48:51], a[12:15], v[76:79], v[48:51]
    v_mfma_f32_16x16x32_bf16 v[52:55], a[16:19], v[76:79], v[52:55]
    ds_read_b128 v[248:251], v23 offset:6144
    buffer_load_dwordx4 v23, s[36:39], s96 offen offset:1024 sc1 lds
    v_mfma_f32_16x16x32_bf16 v[56:59], a[20:23], v[76:79], v[56:59]
    s_waitcnt lgkmcnt(4)
    v_mfma_f32_16x16x32_bf16 v[48:51], a[24:27], v[80:83], v[48:51]
    ds_read_b128 v[252:255], v23 offset:7168
    v_mfma_f32_16x16x32_bf16 v[52:55], a[28:31], v[80:83], v[52:55]
    v_mfma_f32_16x16x32_bf16 v[56:59], a[32:35], v[80:83], v[56:59]
    s_waitcnt vmcnt(8)
    v_add_f32 v40, v40, v42
    v_add_f32 v41, v41, v43
    s_waitcnt lgkmcnt(4)
    v_mfma_f32_16x16x32_bf16 v[48:51], a[36:39], v[84:87], v[48:51]
    buffer_load_dwordx4 v23, s[36:39], s96 offen offset:2048 sc1 lds
    v_mfma_f32_16x16x32_bf16 v[52:55], a[40:43], v[84:87], v[52:55]
    v_permlane16_swap_b32 v40, v41
    v_mfma_f32_16x16x32_bf16 v[56:59], a[44:47], v[84:87], v[56:59]
    v_add_f32 v42, v40, v41
    v_add_f32 v40, v40, v41
    s_waitcnt lgkmcnt(0)
    v_mfma_f32_16x16x32_bf16 v[48:51], a[48:51], v[224:227], v[48:51]
    ds_read_b128 v[72:75], v23 offset:8192
    v_mfma_f32_16x16x32_bf16 v[52:55], a[52:55], v[224:227], v[52:55]
    buffer_load_dwordx4 v23, s[36:39], s96 offen offset:3072 sc1 lds
    s_add_u32 m0, s60, 49152
    v_mfma_f32_16x16x32_bf16 v[56:59], a[56:59], v[224:227], v[56:59]
    ds_read_b128 v[76:79], v23 offset:9216
    s_add_u32 s96, s3, 49152
    v_mfma_f32_16x16x32_bf16 v[48:51], a[60:63], v[228:231], v[48:51]
    v_permlane32_swap_b32 v40, v42
    v_mfma_f32_16x16x32_bf16 v[52:55], a[64:67], v[228:231], v[52:55]
    ds_read_b128 v[80:83], v23 offset:10240
    v_add_f32 v41, v40, v42
    v_mfma_f32_16x16x32_bf16 v[56:59], a[68:71], v[228:231], v[56:59]
    v_add_f32 v40, v40, v42
    v_mfma_f32_16x16x32_bf16 v[48:51], a[72:75], v[248:251], v[48:51]
    ds_read_b128 v[84:87], v23 offset:11264
    buffer_load_dwordx4 v23, s[36:39], s96 offen sc1 lds
    v_mfma_f32_16x16x32_bf16 v[52:55], a[76:79], v[248:251], v[52:55]
    v_permlane16_swap_b32 v40, v41
    v_mfma_f32_16x16x32_bf16 v[56:59], a[80:83], v[248:251], v[56:59]
    v_mul_f32 v40, 0xbb000000, v40
    v_mul_f32 v41, 0x3b000000, v41
    v_mfma_f32_16x16x32_bf16 v[48:51], a[84:87], v[252:255], v[48:51]
    v_fma_f32 v42, -v40, v40, v41
    v_mfma_f32_16x16x32_bf16 v[52:55], a[88:91], v[252:255], v[52:55]
    buffer_load_dwordx4 v23, s[36:39], s96 offen offset:1024 sc1 lds
    v_max_f32 v42, 0, v42
    v_mfma_f32_16x16x32_bf16 v[56:59], a[92:95], v[252:255], v[56:59]
    v_add_f32 v42, 0x3727c5ac, v42
    s_waitcnt lgkmcnt(0)
    v_mfma_f32_16x16x32_bf16 v[48:51], a[96:99], v[72:75], v[48:51]
    ds_read_b128 v[224:227], v23 offset:12288
    v_rsq_f32 v41, v42
    v_mfma_f32_16x16x32_bf16 v[52:55], a[100:103], v[72:75], v[52:55]
    v_mul_f32 v41, 0xbfb8aa3b, v41
    v_mfma_f32_16x16x32_bf16 v[56:59], a[104:107], v[72:75], v[56:59]
    ds_read_b128 v[228:231], v23 offset:13312
    ds_write_b128 v21, v[40:43] offset:0
    v_mfma_f32_16x16x32_bf16 v[48:51], a[108:111], v[76:79], v[48:51]
    buffer_load_dwordx4 v23, s[36:39], s96 offen offset:2048 sc1 lds
    v_mfma_f32_16x16x32_bf16 v[52:55], a[112:115], v[76:79], v[52:55]
    ds_read_b128 v[248:251], v23 offset:14336
    v_mfma_f32_16x16x32_bf16 v[56:59], a[116:119], v[76:79], v[56:59]
    v_mfma_f32_16x16x32_bf16 v[48:51], a[120:123], v[80:83], v[48:51]
    ds_read_b128 v[252:255], v23 offset:15360
    v_mfma_f32_16x16x32_bf16 v[52:55], a[124:127], v[80:83], v[52:55]
    buffer_load_dwordx4 v23, s[36:39], s96 offen offset:3072 sc1 lds
    v_mfma_f32_16x16x32_bf16 v[56:59], a[128:131], v[80:83], v[56:59]
    v_mfma_f32_16x16x32_bf16 v[48:51], a[132:135], v[84:87], v[48:51]
    v_mfma_f32_16x16x32_bf16 v[52:55], a[136:139], v[84:87], v[52:55]
    v_mfma_f32_16x16x32_bf16 v[56:59], a[140:143], v[84:87], v[56:59]
    s_waitcnt vmcnt(8)
    s_waitcnt lgkmcnt(2)
    s_waitcnt lgkmcnt(0)
    v_readfirstlane_b32 s62, v238
    s_nop 1
    s_sub_u32 s62, s62, s49
    s_xor_b32 s62, s62, 32
    s_and_b32 s62, s62, s101
    s_cbranch_scc1 L_cold24
L_cold24_r:
    s_barrier
    v_mfma_f32_16x16x32_bf16 v[48:51], a[144:147], v[224:227], v[48:51]
    ds_read_b128 v[72:75], v23 offset:16384
    v_mov_b32 v238, 0
    buffer_atomic_or v238, v222, s[36:39], s18 offen sc0 sc1
    v_mfma_f32_16x16x32_bf16 v[52:55], a[148:151], v[224:227], v[52:55]
    ds_read_b128 v[88:91], v5 offset:0
    s_add_u32 s97, s16, 0
    v_mfma_f32_16x16x32_bf16 v[56:59], a[152:155], v[224:227], v[56:59]
    ds_read_b128 v[76:79], v23 offset:17408
    v_mfma_f32_16x16x32_bf16 v[48:51], a[156:159], v[228:231], v[48:51]
    v_mfma_f32_16x16x32_bf16 v[52:55], a[160:163], v[228:231], v[52:55]
    ds_read_b128 v[80:83], v23 offset:18432
    buffer_load_dwordx4 a[192:195], v23, s[36:39], s97 offen offset:0 sc1
    v_mfma_f32_16x16x32_bf16 v[56:59], a[164:167], v[228:231], v[56:59]
    v_mfma_f32_16x16x32_bf16 v[48:51], a[168:171], v[248:251], v[48:51]
    ds_read_b128 v[84:87], v23 offset:19456
    v_mfma_f32_16x16x32_bf16 v[52:55], a[172:175], v[248:251], v[52:55]
    v_mfma_f32_16x16x32_bf16 v[56:59], a[176:179], v[248:251], v[56:59]
    v_mfma_f32_16x16x32_bf16 v[48:51], a[180:183], v[252:255], v[48:51]
    buffer_load_dwordx4 a[196:199], v23, s[36:39], s97 offen offset:1024 sc1
    v_mfma_f32_16x16x32_bf16 v[52:55], a[184:187], v[252:255], v[52:55]
    v_mfma_f32_16x16x32_bf16 v[56:59], a[188:191], v[252:255], v[56:59]
    s_waitcnt lgkmcnt(0)
    v_mfma_f32_16x16x32_bf16 v[60:63], a[0:3], v[72:75], 0
    ds_read_b128 v[224:227], v23 offset:20480
    v_mfma_f32_16x16x32_bf16 v[64:67], a[4:7], v[72:75], 0
    s_nop 3
    v_permlane16_swap_b32 v56, v58
    v_mfma_f32_16x16x32_bf16 v[68:71], a[8:11], v[72:75], 0
    ds_read_b128 v[228:231], v23 offset:21504
    buffer_load_dwordx4 a[200:203], v23, s[36:39], s97 offen offset:2048 sc1
    v_mfma_f32_16x16x32_bf16 v[60:63], a[12:15], v[76:79], v[60:63]
    v_permlane16_swap_b32 v57, v59
    v_mfma_f32_16x16x32_bf16 v[64:67], a[16:19], v[76:79], v[64:67]
    ds_read_b128 v[248:251], v23 offset:22528
    v_fmac_f32 v56, v88, v216
    v_mfma_f32_16x16x32_bf16 v[68:71], a[20:23], v[76:79], v[68:71]
    v_fmac_f32 v57, v88, v217
    v_mul_f32 v28, v89, v56
    v_mfma_f32_16x16x32_bf16 v[60:63], a[24:27], v[80:83], v[60:63]
    ds_read_b128 v[252:255], v23 offset:23552
    v_mul_f32 v29, v89, v57
    v_mfma_f32_16x16x32_bf16 v[64:67], a[28:31], v[80:83], v[64:67]
    buffer_load_dwordx4 a[204:207], v23, s[36:39], s97 offen offset:3072 sc1
    s_add_u32 s97, s16, 4096
    v_mfma_f32_16x16x32_bf16 v[68:71], a[32:35], v[80:83], v[68:71]
    v_fmac_f32 v58, v88, v218
    v_fmac_f32 v59, v88, v219
    v_mfma_f32_16x16x32_bf16 v[60:63], a[36:39], v[84:87], v[60:63]
    v_exp_f32 v28, v28
    v_mfma_f32_16x16x32_bf16 v[64:67], a[40:43], v[84:87], v[64:67]
    v_exp_f32 v29, v29
    v_mul_f32 v56, v56, v58
    v_mfma_f32_16x16x32_bf16 v[68:71], a[44:47], v[84:87], v[68:71]
    v_mul_f32 v57, v57, v59
    v_fma_f32 v28, v28, v90, v90
    s_waitcnt lgkmcnt(0)
    v_mfma_f32_16x16x32_bf16 v[60:63], a[48:51], v[224:227], v[60:63]
    ds_read_b128 v[72:75], v23 offset:24576
    buffer_load_dwordx4 a[208:211], v23, s[36:39], s97 offen offset:0 sc1
    v_mfma_f32_16x16x32_bf16 v[64:67], a[52:55], v[224:227], v[64:67]
    v_fma_f32 v29, v29, v90, v90
    v_mfma_f32_16x16x32_bf16 v[68:71], a[56:59], v[224:227], v[68:71]
    ds_read_b128 v[76:79], v23 offset:25600
    v_rcp_f32 v28, v28
    v_mfma_f32_16x16x32_bf16 v[60:63], a[60:63], v[228:231], v[60:63]
    v_rcp_f32 v29, v29
    v_mfma_f32_16x16x32_bf16 v[64:67], a[64:67], v[228:231], v[64:67]
    ds_read_b128 v[80:83], v23 offset:26624
    buffer_load_dwordx4 a[212:215], v23, s[36:39], s97 offen offset:1024 sc1
    v_mfma_f32_16x16x32_bf16 v[68:71], a[68:71], v[228:231], v[68:71]
    v_mul_f32 v56, v56, v28
    v_mul_f32 v57, v57, v29
    v_mfma_f32_16x16x32_bf16 v[60:63], a[72:75], v[248:251], v[60:63]
    ds_read_b128 v[84:87], v23 offset:27648
    v_cvt_pk_bf16_f32 v44, v56, v57
    v_mfma_f32_16x16x32_bf16 v[64:67], a[76:79], v[248:251], v[64:67]
    v_fmac_f32 v48, v88, v208
    v_fmac_f32 v49, v88, v209
    v_mfma_f32_16x16x32_bf16 v[68:71], a[80:83], v[248:251], v[68:71]
    v_fmac_f32 v50, v88, v210
    v_fmac_f32 v51, v88, v211
    v_mfma_f32_16x16x32_bf16 v[60:63], a[84:87], v[252:255], v[60:63]
    buffer_load_dwordx4 a[216:219], v23, s[36:39], s97 offen offset:2048 sc1
    v_mul_f32 v28, v89, v48
    v_mfma_f32_16x16x32_bf16 v[64:67], a[88:91], v[252:255], v[64:67]
    v_mul_f32 v29, v89, v49
    v_mul_f32 v30, v89, v50
    v_mfma_f32_16x16x32_bf16 v[68:71], a[92:95], v[252:255], v[68:71]
    v_mul_f32 v31, v89, v51
    v_fmac_f32 v52, v88, v212
    v_fmac_f32 v53, v88, v213
    s_waitcnt lgkmcnt(0)
    v_mfma_f32_16x16x32_bf16 v[60:63], a[96:99], v[72:75], v[60:63]
    ds_read_b128 v[224:227], v23 offset:28672
    v_fmac_f32 v54, v88, v214
    v_mfma_f32_16x16x32_bf16 v[64:67], a[100:103], v[72:75], v[64:67]
    v_fmac_f32 v55, v88, v215
    v_mfma_f32_16x16x32_bf16 v[68:71], a[104:107], v[72:75], v[68:71]
    ds_read_b128 v[228:231], v23 offset:29696
    buffer_load_dwordx4 a[220:223], v23, s[36:39], s97 offen offset:3072 sc1
    v_mfma_f32_16x16x32_bf16 v[60:63], a[108:111], v[76:79], v[60:63]
    s_add_u32 s97, s16, 8192
    v_exp_f32 v28, v28
    v_mfma_f32_16x16x32_bf16 v[64:67], a[112:115], v[76:79], v[64:67]
    ds_read_b128 v[248:251], v23 offset:30720
    v_mfma_f32_16x16x32_bf16 v[68:71], a[116:119], v[76:79], v[68:71]
    v_exp_f32 v29, v29
    v_mfma_f32_16x16x32_bf16 v[60:63], a[120:123], v[80:83], v[60:63]
    ds_read_b128 v[252:255], v23 offset:31744
    v_exp_f32 v30, v30
    v_mfma_f32_16x16x32_bf16 v[64:67], a[124:127], v[80:83], v[64:67]
    buffer_load_dwordx4 a[224:227], v23, s[36:39], s97 offen offset:0 sc1
    v_mfma_f32_16x16x32_bf16 v[68:71], a[128:131], v[80:83], v[68:71]
    v_exp_f32 v31, v31
    v_mul_f32 v48, v48, v52
    v_mfma_f32_16x16x32_bf16 v[60:63], a[132:135], v[84:87], v[60:63]
    v_mul_f32 v49, v49, v53
    v_mul_f32 v50, v50, v54
    v_mfma_f32_16x16x32_bf16 v[64:67], a[136:139], v[84:87], v[64:67]
    v_mul_f32 v51, v51, v55
    v_fma_f32 v28, v28, v90, v90
    v_mfma_f32_16x16x32_bf16 v[68:71], a[140:143], v[84:87], v[68:71]
    s_waitcnt vmcnt(10)
    s_waitcnt lgkmcnt(0)
    s_waitcnt vmcnt(9)
    v_readfirstlane_b32 s62, v238
    s_nop 1
    s_sub_u32 s62, s62, s49
    s_xor_b32 s62, s62, 16
    s_and_b32 s62, s62, s101
    s_cbranch_scc1 L_cold27
L_cold27_r:
    s_barrier
    v_mfma_f32_16x16x32_bf16 v[60:63], a[144:147], v[224:227], v[60:63]
    ds_read_b128 v[72:75], v23 offset:32768
    s_add_u32 m0, s60, 65536
    s_add_u32 s96, s3, 65536
    buffer_load_dwordx4 v23, s[36:39], s96 offen sc1 lds
    v_mfma_f32_16x16x32_bf16 v[64:67], a[148:151], v[224:227], v[64:67]
    ds_read_b128 v[36:39], v5 offset:1024
    v_fma_f32 v29, v29, v90, v90
    v_mfma_f32_16x16x32_bf16 v[68:71], a[152:155], v[224:227], v[68:71]
    ds_read_b128 v[76:79], v23 offset:33792
    v_fma_f32 v30, v30, v90, v90
    v_mfma_f32_16x16x32_bf16 v[60:63], a[156:159], v[228:231], v[60:63]
    v_fma_f32 v31, v31, v90, v90
    v_mfma_f32_16x16x32_bf16 v[64:67], a[160:163], v[228:231], v[64:67]
    ds_read_b128 v[80:83], v23 offset:34816
    v_rcp_f32 v28, v28
    v_mfma_f32_16x16x32_bf16 v[68:71], a[164:167], v[228:231], v[68:71]
    buffer_load_dwordx4 v23, s[36:39], s96 offen offset:1024 sc1 lds
    v_rcp_f32 v29, v29
    v_mfma_f32_16x16x32_bf16 v[60:63], a[168:171], v[248:251], v[60:63]
    ds_read_b128 v[84:87], v23 offset:35840
    v_mfma_f32_16x16x32_bf16 v[64:67], a[172:175], v[248:251], v[64:67]
    v_rcp_f32 v30, v30
    v_mfma_f32_16x16x32_bf16 v[68:71], a[176:179], v[248:251], v[68:71]
    v_rcp_f32 v31, v31
    v_mul_f32 v48, v48, v28
    v_mfma_f32_16x16x32_bf16 v[60:63], a[180:183], v[252:255], v[60:63]
    v_mul_f32 v49, v49, v29
    v_mul_f32 v50, v50, v30
    v_mfma_f32_16x16x32_bf16 v[64:67], a[184:187], v[252:255], v[64:67]
    v_mul_f32 v51, v51, v31
    v_cvt_pk_bf16_f32 v92, v48, v49
    v_mfma_f32_16x16x32_bf16 v[68:71], a[188:191], v[252:255], v[68:71]
    buffer_load_dwordx4 v23, s[36:39], s96 offen offset:2048 sc1 lds
    v_cvt_pk_bf16_f32 v93, v50, v51
    s_waitcnt lgkmcnt(0)
    v_mfma_f32_16x16x32_bf16 v[48:51], a[0:3], v[72:75], 0
    ds_read_b128 v[224:227], v23 offset:36864
    v_mfma_f32_16x16x32_bf16 v[52:55], a[4:7], v[72:75], 0
    s_nop 1
    v_permlane16_swap_b32 v68, v70
    v_mfma_f32_16x16x32_bf16 v[56:59], a[8:11], v[72:75], 0
    ds_read_b128 v[228:231], v23 offset:37888
    v_mfma_f32_16x16x32_bf16 v[48:51], a[12:15], v[76:79], v[48:51]
    v_permlane16_swap_b32 v69, v71
    v_fmac_f32 v68, v36, v216
    v_mfma_f32_16x16x32_bf16 v[52:55], a[16:19], v[76:79], v[52:55]
    ds_read_b128 v[248:251], v23 offset:38912
    v_fmac_f32 v69, v36, v217
    v_mul_f32 v28, v37, v68
    v_mfma_f32_16x16x32_bf16 v[56:59], a[20:23], v[76:79], v[56:59]
    buffer_load_dwordx4 v23, s[36:39], s96 offen offset:3072 sc1 lds
    v_mul_f32 v29, v37, v69
    v_mfma_f32_16x16x32_bf16 v[48:51], a[24:27], v[80:83], v[48:51]
    ds_read_b128 v[252:255], v23 offset:39936
    v_fmac_f32 v70, v36, v218
    v_mfma_f32_16x16x32_bf16 v[52:55], a[28:31], v[80:83], v[52:55]
    v_fmac_f32 v71, v36, v219
    v_mfma_f32_16x16x32_bf16 v[56:59], a[32:35], v[80:83], v[56:59]
    v_exp_f32 v28, v28
    v_mfma_f32_16x16x32_bf16 v[48:51], a[36:39], v[84:87], v[48:51]
    v_exp_f32 v29, v29
    v_mul_f32 v68, v68, v70
    v_mfma_f32_16x16x32_bf16 v[52:55], a[40:43], v[84:87], v[52:55]
    v_mul_f32 v69, v69, v71
    v_fma_f32 v28, v28, v38, v38
    v_mfma_f32_16x16x32_bf16 v[56:59], a[44:47], v[84:87], v[56:59]
    buffer_load_dwordx2 v[40:41], v7, s[36:39], s17 offen offset:512 sc1
    v_fma_f32 v29, v29, v38, v38
    s_waitcnt lgkmcnt(0)
    v_mfma_f32_16x16x32_bf16 v[48:51], a[48:51], v[224:227], v[48:51]
    ds_read_b128 v[72:75], v23 offset:40960
    v_rcp_f32 v28, v28
    v_mfma_f32_16x16x32_bf16 v[52:55], a[52:55], v[224:227], v[52:55]
    v_rcp_f32 v29, v29
    v_mfma_f32_16x16x32_bf16 v[56:59], a[56:59], v[224:227], v[56:59]
    ds_read_b128 v[76:79], v23 offset:41984
    v_mul_f32 v68, v68, v28
    v_mfma_f32_16x16x32_bf16 v[48:51], a[60:63], v[228:231], v[48:51]
    v_mul_f32 v69, v69, v29
    v_cvt_pk_bf16_f32 v45, v68, v69
    v_mfma_f32_16x16x32_bf16 v[52:55], a[64:67], v[228:231], v[52:55]
    ds_read_b128 v[80:83], v23 offset:43008
    buffer_load_dwordx2 v[42:43], v7, s[36:39], s17 offen offset:1536 sc1
    v_mfma_f32_16x16x32_bf16 v[56:59], a[68:71], v[228:231], v[56:59]
    v_permlane16_swap_b32 v44, v45
    buffer_store_dwordx2 v[44:45], v6, s[36:39], s15 offen sc1
    v_mfma_f32_16x16x32_bf16 v[48:51], a[72:75], v[248:251], v[48:51]
    ds_read_b128 v[84:87], v23 offset:44032
    v_fmac_f32 v60, v36, v208
    v_mfma_f32_16x16x32_bf16 v[52:55], a[76:79], v[248:251], v[52:55]
    v_fmac_f32 v61, v36, v209
    v_fmac_f32 v62, v36, v210
    v_mfma_f32_16x16x32_bf16 v[56:59], a[80:83], v[248:251], v[56:59]
    v_fmac_f32 v63, v36, v211
    v_mul_f32 v28, v37, v60
    v_mfma_f32_16x16x32_bf16 v[48:51], a[84:87], v[252:255], v[48:51]
    v_mul_f32 v29, v37, v61
    v_mul_f32 v30, v37, v62
    v_mfma_f32_16x16x32_bf16 v[52:55], a[88:91], v[252:255], v[52:55]
    buffer_load_dwordx4 a[228:231], v23, s[36:39], s97 offen offset:1024 sc1
    v_mul_f32 v31, v37, v63
    v_mfma_f32_16x16x32_bf16 v[56:59], a[92:95], v[252:255], v[56:59]
    v_fmac_f32 v64, v36, v212
    v_fmac_f32 v65, v36, v213
    s_waitcnt lgkmcnt(0)
    v_mfma_f32_16x16x32_bf16 v[48:51], a[96:99], v[72:75], v[48:51]
    ds_read_b128 v[224:227], v23 offset:45056
    v_fmac_f32 v66, v36, v214
    v_fmac_f32 v67, v36, v215
    v_mfma_f32_16x16x32_bf16 v[52:55], a[100:103], v[72:75], v[52:55]
    v_exp_f32 v28, v28
    v_mfma_f32_16x16x32_bf16 v[56:59], a[104:107], v[72:75], v[56:59]
    ds_read_b128 v[228:231], v23 offset:46080
    v_mfma_f32_16x16x32_bf16 v[48:51], a[108:111], v[76:79], v[48:51]
    v_exp_f32 v29, v29
    v_mfma_f32_16x16x32_bf16 v[52:55], a[112:115], v[76:79], v[52:55]
    ds_read_b128 v[248:251], v23 offset:47104
    buffer_load_dwordx4 a[232:235], v23, s[36:39], s97 offen offset:2048 sc1
    v_mfma_f32_16x16x32_bf16 v[56:59], a[116:119], v[76:79], v[56:59]
    s_add_u32 m0, s60, 81920
    s_add_u32 s96, s3, 81920
    v_mfma_f32_16x16x32_bf16 v[48:51], a[120:123], v[80:83], v[48:51]
    ds_read_b128 v[252:255], v23 offset:48128
    v_exp_f32 v30, v30
    v_mfma_f32_16x16x32_bf16 v[52:55], a[124:127], v[80:83], v[52:55]
    v_exp_f32 v31, v31
    v_mul_f32 v60, v60, v64
    v_mfma_f32_16x16x32_bf16 v[56:59], a[128:131], v[80:83], v[56:59]
    v_mul_f32 v61, v61, v65
    v_mul_f32 v62, v62, v66
    v_mfma_f32_16x16x32_bf16 v[48:51], a[132:135], v[84:87], v[48:51]
    v_mul_f32 v63, v63, v67
    v_fma_f32 v28, v28, v38, v38
    v_mfma_f32_16x16x32_bf16 v[52:55], a[136:139], v[84:87], v[52:55]
    buffer_load_dwordx4 v23, s[36:39], s96 offen sc1 lds
    v_fma_f32 v29, v29, v38, v38
    v_mfma_f32_16x16x32_bf16 v[56:59], a[140:143], v[84:87], v[56:59]
    v_fma_f32 v30, v30, v38, v38
    v_fma_f32 v31, v31, v38, v38
    s_waitcnt lgkmcnt(0)
    v_mfma_f32_16x16x32_bf16 v[48:51], a[144:147], v[224:227], v[48:51]
    ds_read_b128 v[72:75], v23 offset:49152
    v_mfma_f32_16x16x32_bf16 v[52:55], a[148:151], v[224:227], v[52:55]
    ds_read_b128 v[88:91], v5 offset:2048
    v_rcp_f32 v28, v28
    v_mfma_f32_16x16x32_bf16 v[56:59], a[152:155], v[224:227], v[56:59]
    ds_read_b128 v[76:79], v23 offset:50176
    v_rcp_f32 v29, v29
    v_mfma_f32_16x16x32_bf16 v[48:51], a[156:159], v[228:231], v[48:51]
    v_rcp_f32 v30, v30
    v_mfma_f32_16x16x32_bf16 v[52:55], a[160:163], v[228:231], v[52:55]
    ds_read_b128 v[80:83], v23 offset:51200
    buffer_load_dwordx4 v23, s[36:39], s96 offen offset:1024 sc1 lds
    v_mfma_f32_16x16x32_bf16 v[56:59], a[164:167], v[228:231], v[56:59]
    v_rcp_f32 v31, v31
    v_mfma_f32_16x16x32_bf16 v[48:51], a[168:171], v[248:251], v[48:51]
    ds_read_b128 v[84:87], v23 offset:52224
    v_mul_f32 v60, v60, v28
    v_mfma_f32_16x16x32_bf16 v[52:55], a[172:175], v[248:251], v[52:55]
    v_mul_f32 v61, v61, v29
    v_mul_f32 v62, v62, v30
    v_mfma_f32_16x16x32_bf16 v[56:59], a[176:179], v[248:251], v[56:59]
    v_mul_f32 v63, v63, v31
    v_cvt_pk_bf16_f32 v94, v60, v61
    v_cvt_pk_bf16_f32 v95, v62, v63
    v_mfma_f32_16x16x32_bf16 v[48:51], a[180:183], v[252:255], v[48:51]
    buffer_load_dwordx4 v23, s[36:39], s96 offen offset:2048 sc1 lds
    v_mfma_f32_16x16x32_bf16 v[52:55], a[184:187], v[252:255], v[52:55]
    v_permlane16_swap_b32 v92, v94
    v_mfma_f32_16x16x32_bf16 v[56:59], a[188:191], v[252:255], v[56:59]
    v_permlane16_swap_b32 v93, v95
    buffer_store_dwordx4 v[92:95], v20, s[36:39], s4 offen sc1
    s_waitcnt lgkmcnt(0)
    v_mfma_f32_16x16x32_bf16 v[60:63], a[0:3], v[72:75], 0
    ds_read_b128 v[224:227], v23 offset:53248
    v_mfma_f32_16x16x32_bf16 v[64:67], a[4:7], v[72:75], 0
    s_nop 1
    v_permlane16_swap_b32 v56, v58
    v_mfma_f32_16x16x32_bf16 v[68:71], a[8:11], v[72:75], 0
    ds_read_b128 v[228:231], v23 offset:54272
    v_permlane16_swap_b32 v57, v59
    v_mfma_f32_16x16x32_bf16 v[60:63], a[12:15], v[76:79], v[60:63]
    buffer_load_dwordx4 v23, s[36:39], s96 offen offset:3072 sc1 lds
    s_add_u32 m0, s60, 98304
    v_mfma_f32_16x16x32_bf16 v[64:67], a[16:19], v[76:79], v[64:67]
    ds_read_b128 v[248:251], v23 offset:55296
    s_add_u32 s96, s3, 98304
    v_mfma_f32_16x16x32_bf16 v[68:71], a[20:23], v[76:79], v[68:71]
    v_fmac_f32 v56, v88, v216
    v_fmac_f32 v57, v88, v217
    v_mfma_f32_16x16x32_bf16 v[60:63], a[24:27], v[80:83], v[60:63]
    ds_read_b128 v[252:255], v23 offset:56320
    s_waitcnt vmcnt(8)
    v_add_f32 v40, v40, v42
    v_mul_f32 v28, v89, v56
    v_mfma_f32_16x16x32_bf16 v[64:67], a[28:31], v[80:83], v[64:67]
    v_mul_f32 v29, v89, v57
    v_fmac_f32 v58, v88, v218
    v_mfma_f32_16x16x32_bf16 v[68:71], a[32:35], v[80:83], v[68:71]
    v_add_f32 v41, v41, v43
    v_fmac_f32 v59, v88, v219
    v_mfma_f32_16x16x32_bf16 v[60:63], a[36:39], v[84:87], v[60:63]
    buffer_load_dwordx4 v23, s[36:39], s96 offen sc1 lds
    v_mfma_f32_16x16x32_bf16 v[64:67], a[40:43], v[84:87], v[64:67]
    v_exp_f32 v28, v28
    v_exp_f32 v29, v29
    v_mfma_f32_16x16x32_bf16 v[68:71], a[44:47], v[84:87], v[68:71]
    v_mul_f32 v56, v56, v58
    v_mul_f32 v57, v57, v59
    s_waitcnt lgkmcnt(0)
    v_mfma_f32_16x16x32_bf16 v[60:63], a[48:51], v[224:227], v[60:63]
    ds_read_b128 v[72:75], v23 offset:57344
    v_fma_f32 v28, v28, v90, v90
    v_mfma_f32_16x16x32_bf16 v[64:67], a[52:55], v[224:227], v[64:67]
    v_fma_f32 v29, v29, v90, v90
    v_mfma_f32_16x16x32_bf16 v[68:71], a[56:59], v[224:227], v[68:71]
    ds_read_b128 v[76:79], v23 offset:58368
    v_rcp_f32 v28, v28
    v_mfma_f32_16x16x32_bf16 v[60:63], a[60:63], v[228:231], v[60:63]
    buffer_load_dwordx4 v23, s[36:39], s96 offen offset:1024 sc1 lds
    v_permlane16_swap_b32 v40, v41
    v_mfma_f32_16x16x32_bf16 v[64:67], a[64:67], v[228:231], v[64:67]
    ds_read_b128 v[80:83], v23 offset:59392
    v_rcp_f32 v29, v29
    v_mfma_f32_16x16x32_bf16 v[68:71], a[68:71], v[228:231], v[68:71]
    v_mul_f32 v56, v56, v28
    v_mul_f32 v57, v57, v29
    v_mfma_f32_16x16x32_bf16 v[60:63], a[72:75], v[248:251], v[60:63]
    ds_read_b128 v[84:87], v23 offset:60416
    v_add_f32 v42, v40, v41
    v_cvt_pk_bf16_f32 v44, v56, v57
    v_mfma_f32_16x16x32_bf16 v[64:67], a[76:79], v[248:251], v[64:67]
    v_fmac_f32 v48, v88, v208
    v_fmac_f32 v49, v88, v209
    v_mfma_f32_16x16x32_bf16 v[68:71], a[80:83], v[248:251], v[68:71]
    buffer_load_dwordx4 v23, s[36:39], s96 offen offset:2048 sc1 lds
    v_fmac_f32 v50, v88, v210
    v_mfma_f32_16x16x32_bf16 v[60:63], a[84:87], v[252:255], v[60:63]
    v_add_f32 v40, v40, v41
    v_fmac_f32 v51, v88, v211
    v_mfma_f32_16x16x32_bf16 v[64:67], a[88:91], v[252:255], v[64:67]
    v_mul_f32 v28, v89, v48
    v_mul_f32 v29, v89, v49
    v_mul_f32 v30, v89, v50
    v_mfma_f32_16x16x32_bf16 v[68:71], a[92:95], v[252:255], v[68:71]
    v_mul_f32 v31, v89, v51
    v_fmac_f32 v52, v88, v212
    s_waitcnt lgkmcnt(0)
    v_mfma_f32_16x16x32_bf16 v[60:63], a[96:99], v[72:75], v[60:63]
    ds_read_b128 v[224:227], v23 offset:61440
    v_fmac_f32 v53, v88, v213
    v_mfma_f32_16x16x32_bf16 v[64:67], a[100:103], v[72:75], v[64:67]
    v_fmac_f32 v54, v88, v214
    v_fmac_f32 v55, v88, v215
    v_mfma_f32_16x16x32_bf16 v[68:71], a[104:107], v[72:75], v[68:71]
    ds_read_b128 v[228:231], v23 offset:62464
    buffer_load_dwordx4 v23, s[36:39], s96 offen offset:3072 sc1 lds
    v_mfma_f32_16x16x32_bf16 v[60:63], a[108:111], v[76:79], v[60:63]
    v_permlane32_swap_b32 v40, v42
    v_mfma_f32_16x16x32_bf16 v[64:67], a[112:115], v[76:79], v[64:67]
    ds_read_b128 v[248:251], v23 offset:63488
    v_exp_f32 v28, v28
    v_mfma_f32_16x16x32_bf16 v[68:71], a[116:119], v[76:79], v[68:71]
    v_exp_f32 v29, v29
    v_mfma_f32_16x16x32_bf16 v[60:63], a[120:123], v[80:83], v[60:63]
    ds_read_b128 v[252:255], v23 offset:64512
    v_exp_f32 v30, v30
    v_mfma_f32_16x16x32_bf16 v[64:67], a[124:127], v[80:83], v[64:67]
    v_add_f32 v41, v40, v42
    v_mfma_f32_16x16x32_bf16 v[68:71], a[128:131], v[80:83], v[68:71]
    buffer_load_dwordx4 a[236:239], v23, s[36:39], s97 offen offset:3072 sc1
    s_add_u32 s97, s16, 12288
    s_branch L_pgo5
L_pg5:
    s_branch L_pgback5
L_pgo5:
    v_mfma_f32_16x16x32_bf16 v[60:63], a[132:135], v[84:87], v[60:63]
    v_exp_f32 v31, v31
    v_mul_f32 v48, v48, v52
    v_mul_f32 v49, v49, v53
    v_mfma_f32_16x16x32_bf16 v[64:67], a[136:139], v[84:87], v[64:67]
    v_add_f32 v40, v40, v42
    v_mul_f32 v50, v50, v54
    v_mfma_f32_16x16x32_bf16 v[68:71], a[140:143], v[84:87], v[68:71]
    v_mul_f32 v51, v51, v55
    s_waitcnt lgkmcnt(0)
    s_barrier
    v_mfma_f32_16x16x32_bf16 v[60:63], a[144:147], v[224:227], v[60:63]
    ds_read_b128 v[72:75], v4 offset:0
    v_fma_f32 v28, v28, v90, v90
    v_mfma_f32_16x16x32_bf16 v[64:67], a[148:151], v[224:227], v[64:67]
    ds_read_b128 v[36:39], v5 offset:3072
    v_fma_f32 v29, v29, v90, v90
    v_fma_f32 v30, v30, v90, v90
    v_mfma_f32_16x16x32_bf16 v[68:71], a[152:155], v[224:227], v[68:71]
    ds_read_b128 v[76:79], v4 offset:1024
    buffer_load_dwordx4 a[240:243], v23, s[36:39], s97 offen offset:0 sc1
    v_mfma_f32_16x16x32_bf16 v[60:63], a[156:159], v[228:231], v[60:63]
    v_fma_f32 v31, v31, v90, v90
    v_mfma_f32_16x16x32_bf16 v[64:67], a[160:163], v[228:231], v[64:67]
    ds_read_b128 v[80:83], v4 offset:2048
    v_rcp_f32 v28, v28
    v_mfma_f32_16x16x32_bf16 v[68:71], a[164:167], v[228:231], v[68:71]
    v_rcp_f32 v29, v29
    v_mfma_f32_16x16x32_bf16 v[60:63], a[168:171], v[248:251], v[60:63]
    ds_read_b128 v[84:87], v4 offset:3072
    v_permlane16_swap_b32 v40, v41
    v_mfma_f32_16x16x32_bf16 v[64:67], a[172:175], v[248:251], v[64:67]
    v_rcp_f32 v30, v30
    v_mfma_f32_16x16x32_bf16 v[68:71], a[176:179], v[248:251], v[68:71]
    buffer_load_dwordx4 a[244:247], v23, s[36:39], s97 offen offset:1024 sc1
    v_rcp_f32 v31, v31
    v_mfma_f32_16x16x32_bf16 v[60:63], a[180:183], v[252:255], v[60:63]
    v_mul_f32 v40, 0xbb000000, v40
    v_mul_f32 v48, v48, v28
    v_mfma_f32_16x16x32_bf16 v[64:67], a[184:187], v[252:255], v[64:67]
    v_mul_f32 v49, v49, v29
    v_mul_f32 v50, v50, v30
    v_mul_f32 v51, v51, v31
    v_mfma_f32_16x16x32_bf16 v[68:71], a[188:191], v[252:255], v[68:71]
    v_cvt_pk_bf16_f32 v92, v48, v49
    v_cvt_pk_bf16_f32 v93, v50, v51
    s_waitcnt lgkmcnt(0)
    v_mfma_f32_16x16x32_bf16 v[48:51], a[0:3], v[72:75], 0
    ds_read_b128 v[224:227], v4 offset:4096
    v_mul_f32 v41, 0x3b000000, v41
    v_mfma_f32_16x16x32_bf16 v[52:55], a[4:7], v[72:75], 0
    buffer_load_dwordx4 a[248:251], v23, s[36:39], s97 offen offset:2048 sc1
    v_mfma_f32_16x16x32_bf16 v[56:59], a[8:11], v[72:75], 0
    ds_read_b128 v[228:231], v4 offset:5120
    v_permlane16_swap_b32 v68, v70
    v_mfma_f32_16x16x32_bf16 v[48:51], a[12:15], v[76:79], v[48:51]
    v_fma_f32 v42, -v40, v40, v41
    v_permlane16_swap_b32 v69, v71
    v_mfma_f32_16x16x32_bf16 v[52:55], a[16:19], v[76:79], v[52:55]
    ds_read_b128 v[248:251], v4 offset:6144
    v_fmac_f32 v68, v36, v216
    v_fmac_f32 v69, v36, v217
    v_mfma_f32_16x16x32_bf16 v[56:59], a[20:23], v[76:79], v[56:59]
    v_mul_f32 v28, v37, v68
    v_mul_f32 v29, v37, v69
    v_mfma_f32_16x16x32_bf16 v[48:51], a[24:27], v[80:83], v[48:51]
    ds_read_b128 v[252:255], v4 offset:7168
    v_fmac_f32 v70, v36, v218
    v_mfma_f32_16x16x32_bf16 v[52:55], a[28:31], v[80:83], v[52:55]
    buffer_load_dwordx4 a[252:255], v23, s[36:39], s97 offen offset:3072 sc1
    s_add_u32 s97, s16, 16384
    v_fmac_f32 v71, v36, v219
    v_mfma_f32_16x16x32_bf16 v[56:59], a[32:35], v[80:83], v[56:59]
    v_max_f32 v42, 0, v42
    v_mfma_f32_16x16x32_bf16 v[48:51], a[36:39], v[84:87], v[48:51]
    v_exp_f32 v28, v28
    v_mfma_f32_16x16x32_bf16 v[52:55], a[40:43], v[84:87], v[52:55]
    v_add_f32 v42, 0x3727c5ac, v42
    v_exp_f32 v29, v29
    v_mul_f32 v68, v68, v70
    v_mfma_f32_16x16x32_bf16 v[56:59], a[44:47], v[84:87], v[56:59]
    v_mul_f32 v69, v69, v71
    v_fma_f32 v28, v28, v38, v38
    s_waitcnt lgkmcnt(0)
    v_mfma_f32_16x16x32_bf16 v[48:51], a[48:51], v[224:227], v[48:51]
    ds_read_b128 v[72:75], v4 offset:8192
    v_fma_f32 v29, v29, v38, v38
    v_mfma_f32_16x16x32_bf16 v[52:55], a[52:55], v[224:227], v[52:55]
    buffer_load_dwordx4 v[96:99], v23, s[36:39], s97 offen offset:0 sc1
    v_rcp_f32 v28, v28
    v_mfma_f32_16x16x32_bf16 v[56:59], a[56:59], v[224:227], v[56:59]
    ds_read_b128 v[76:79], v4 offset:9216
    v_mfma_f32_16x16x32_bf16 v[48:51], a[60:63], v[228:231], v[48:51]
    v_rcp_f32 v29, v29
    s_add_u32 s15, s15, 45056
    v_mul_f32 v68, v68, v28
    v_mfma_f32_16x16x32_bf16 v[52:55], a[64:67], v[228:231], v[52:55]
    ds_read_b128 v[80:83], v4 offset:10240
    v_mul_f32 v69, v69, v29
    v_mfma_f32_16x16x32_bf16 v[56:59], a[68:71], v[228:231], v[56:59]
    v_rsq_f32 v41, v42
    v_cvt_pk_bf16_f32 v45, v68, v69
    v_mfma_f32_16x16x32_bf16 v[48:51], a[72:75], v[248:251], v[48:51]
    ds_read_b128 v[84:87], v4 offset:11264
    v_mfma_f32_16x16x32_bf16 v[52:55], a[76:79], v[248:251], v[52:55]
    buffer_load_dwordx4 v[100:103], v23, s[36:39], s97 offen offset:1024 sc1
    v_permlane16_swap_b32 v44, v45
    v_mfma_f32_16x16x32_bf16 v[56:59], a[80:83], v[248:251], v[56:59]
    v_mul_f32 v41, 0xbfb8aa3b, v41
    buffer_store_dwordx2 v[44:45], v6, s[36:39], s15 offen sc1
    v_fmac_f32 v60, v36, v208
    v_mfma_f32_16x16x32_bf16 v[48:51], a[84:87], v[252:255], v[48:51]
    v_fmac_f32 v61, v36, v209
    v_fmac_f32 v62, v36, v210
    v_mfma_f32_16x16x32_bf16 v[52:55], a[88:91], v[252:255], v[52:55]
    ds_write_b128 v21, v[40:43] offset:4096
    v_fmac_f32 v63, v36, v211
    v_mfma_f32_16x16x32_bf16 v[56:59], a[92:95], v[252:255], v[56:59]
    v_mul_f32 v28, v37, v60
    v_mul_f32 v29, v37, v61
    v_mul_f32 v30, v37, v62
    s_waitcnt lgkmcnt(1)
    v_mfma_f32_16x16x32_bf16 v[48:51], a[96:99], v[72:75], v[48:51]
    ds_read_b128 v[224:227], v4 offset:12288
    buffer_load_dwordx4 v[104:107], v23, s[36:39], s97 offen offset:2048 sc1
    v_mfma_f32_16x16x32_bf16 v[52:55], a[100:103], v[72:75], v[52:55]
    s_add_u32 m0, s60, 114688
    s_add_u32 s96, s3, 114688
    v_mul_f32 v31, v37, v63
    v_mfma_f32_16x16x32_bf16 v[56:59], a[104:107], v[72:75], v[56:59]
    ds_read_b128 v[228:231], v4 offset:13312
    v_fmac_f32 v64, v36, v212
    v_mfma_f32_16x16x32_bf16 v[48:51], a[108:111], v[76:79], v[48:51]
    v_fmac_f32 v65, v36, v213
    v_fmac_f32 v66, v36, v214
    v_mfma_f32_16x16x32_bf16 v[52:55], a[112:115], v[76:79], v[52:55]
    ds_read_b128 v[248:251], v4 offset:14336
    v_fmac_f32 v67, v36, v215
    v_mfma_f32_16x16x32_bf16 v[56:59], a[116:119], v[76:79], v[56:59]
    v_exp_f32 v28, v28
    v_mfma_f32_16x16x32_bf16 v[48:51], a[120:123], v[80:83], v[48:51]
    ds_read_b128 v[252:255], v4 offset:15360
    buffer_load_dwordx4 v23, s[36:39], s96 offen sc1 lds
    v_mfma_f32_16x16x32_bf16 v[52:55], a[124:127], v[80:83], v[52:55]
    v_exp_f32 v29, v29
    v_exp_f32 v30, v30
    v_mfma_f32_16x16x32_bf16 v[56:59], a[128:131], v[80:83], v[56:59]
    v_exp_f32 v31, v31
    v_mfma_f32_16x16x32_bf16 v[48:51], a[132:135], v[84:87], v[48:51]
    v_mul_f32 v60, v60, v64
    v_mul_f32 v61, v61, v65
    v_mul_f32 v62, v62, v66
    v_mfma_f32_16x16x32_bf16 v[52:55], a[136:139], v[84:87], v[52:55]
    v_mul_f32 v63, v63, v67
    v_fma_f32 v28, v28, v38, v38
    v_mfma_f32_16x16x32_bf16 v[56:59], a[140:143], v[84:87], v[56:59]
    v_fma_f32 v29, v29, v38, v38
    s_waitcnt vmcnt(10)
    s_waitcnt lgkmcnt(2)
    s_waitcnt lgkmcnt(0)
    s_barrier
    v_mfma_f32_16x16x32_bf16 v[48:51], a[144:147], v[224:227], v[48:51]
    ds_read_b128 v[72:75], v4 offset:16384
    buffer_load_dwordx4 v23, s[36:39], s96 offen offset:1024 sc1 lds
    v_fma_f32 v30, v30, v38, v38
    v_mfma_f32_16x16x32_bf16 v[52:55], a[148:151], v[224:227], v[52:55]
    ds_read_b128 v[88:91], v5 offset:4096
    v_fma_f32 v31, v31, v38, v38
    v_mfma_f32_16x16x32_bf16 v[56:59], a[152:155], v[224:227], v[56:59]
    ds_read_b128 v[76:79], v4 offset:17408
    v_rcp_f32 v28, v28
    v_mfma_f32_16x16x32_bf16 v[48:51], a[156:159], v[228:231], v[48:51]
    v_rcp_f32 v29, v29
    v_mfma_f32_16x16x32_bf16 v[52:55], a[160:163], v[228:231], v[52:55]
    ds_read_b128 v[80:83], v4 offset:18432
    v_mfma_f32_16x16x32_bf16 v[56:59], a[164:167], v[228:231], v[56:59]
    v_rcp_f32 v30, v30
    v_rcp_f32 v31, v31
    v_mfma_f32_16x16x32_bf16 v[48:51], a[168:171], v[248:251], v[48:51]
    ds_read_b128 v[84:87], v4 offset:19456
    buffer_load_dwordx4 v23, s[36:39], s96 offen offset:2048 sc1 lds
    v_mfma_f32_16x16x32_bf16 v[52:55], a[172:175], v[248:251], v[52:55]
    s_add_u32 s4, s4, 45056
    v_mul_f32 v60, v60, v28
    v_mfma_f32_16x16x32_bf16 v[56:59], a[176:179], v[248:251], v[56:59]
    v_mul_f32 v61, v61, v29
    v_mul_f32 v62, v62, v30
    v_mul_f32 v63, v63, v31
    v_mfma_f32_16x16x32_bf16 v[48:51], a[180:183], v[252:255], v[48:51]
    v_cvt_pk_bf16_f32 v94, v60, v61
    v_cvt_pk_bf16_f32 v95, v62, v63
    v_mfma_f32_16x16x32_bf16 v[52:55], a[184:187], v[252:255], v[52:55]
    v_permlane16_swap_b32 v92, v94
    v_mfma_f32_16x16x32_bf16 v[56:59], a[188:191], v[252:255], v[56:59]
    v_permlane16_swap_b32 v93, v95
    buffer_store_dwordx4 v[92:95], v20, s[36:39], s4 offen sc1
    s_waitcnt lgkmcnt(0)
    v_mfma_f32_16x16x32_bf16 v[60:63], a[0:3], v[72:75], 0
    ds_read_b128 v[224:227], v4 offset:20480
    buffer_load_dwordx4 v23, s[36:39], s96 offen offset:3072 sc1 lds
    v_mfma_f32_16x16x32_bf16 v[64:67], a[4:7], v[72:75], 0
    s_nop 0
    v_permlane16_swap_b32 v56, v58
    v_mfma_f32_16x16x32_bf16 v[68:71], a[8:11], v[72:75], 0
    ds_read_b128 v[228:231], v4 offset:21504
    v_mfma_f32_16x16x32_bf16 v[60:63], a[12:15], v[76:79], v[60:63]
    v_permlane16_swap_b32 v57, v59
    v_fmac_f32 v56, v88, v216
    v_mfma_f32_16x16x32_bf16 v[64:67], a[16:19], v[76:79], v[64:67]
    ds_read_b128 v[248:251], v4 offset:22528
    v_fmac_f32 v57, v88, v217
    v_mfma_f32_16x16x32_bf16 v[68:71], a[20:23], v[76:79], v[68:71]
    buffer_load_dwordx4 v[108:111], v23, s[36:39], s97 offen offset:3072 sc1
    s_add_u32 s97, s16, 20480
    v_mfma_f32_16x16x32_bf16 v[60:63], a[24:27], v[80:83], v[60:63]
    ds_read_b128 v[252:255], v4 offset:23552
    v_mul_f32 v28, v89, v56
    v_mfma_f32_16x16x32_bf16 v[64:67], a[28:31], v[80:83], v[64:67]
    v_mul_f32 v29, v89, v57
    v_fmac_f32 v58, v88, v218
    v_mfma_f32_16x16x32_bf16 v[68:71], a[32:35], v[80:83], v[68:71]
    v_fmac_f32 v59, v88, v219
    v_mfma_f32_16x16x32_bf16 v[60:63], a[36:39], v[84:87], v[60:63]
    v_exp_f32 v28, v28
    v_mfma_f32_16x16x32_bf16 v[64:67], a[40:43], v[84:87], v[64:67]
    v_exp_f32 v29, v29
    v_mul_f32 v56, v56, v58
    v_mfma_f32_16x16x32_bf16 v[68:71], a[44:47], v[84:87], v[68:71]
    buffer_load_dwordx4 v[112:115], v23, s[36:39], s97 offen offset:0 sc1
    v_mul_f32 v57, v57, v59
    s_waitcnt lgkmcnt(0)
    v_mfma_f32_16x16x32_bf16 v[60:63], a[48:51], v[224:227], v[60:63]
    ds_read_b128 v[72:75], v4 offset:24576
    v_fma_f32 v28, v28, v90, v90
    v_mfma_f32_16x16x32_bf16 v[64:67], a[52:55], v[224:227], v[64:67]
    v_fma_f32 v29, v29, v90, v90
    v_mfma_f32_16x16x32_bf16 v[68:71], a[56:59], v[224:227], v[68:71]
    ds_read_b128 v[76:79], v4 offset:25600
    v_rcp_f32 v28, v28
    v_mfma_f32_16x16x32_bf16 v[60:63], a[60:63], v[228:231], v[60:63]
    v_rcp_f32 v29, v29
    v_mfma_f32_16x16x32_bf16 v[64:67], a[64:67], v[228:231], v[64:67]
    ds_read_b128 v[80:83], v4 offset:26624
    v_mul_f32 v56, v56, v28
    v_mfma_f32_16x16x32_bf16 v[68:71], a[68:71], v[228:231], v[68:71]
    buffer_load_dwordx4 v[116:119], v23, s[36:39], s97 offen offset:1024 sc1
    v_mul_f32 v57, v57, v29
    v_mfma_f32_16x16x32_bf16 v[60:63], a[72:75], v[248:251], v[60:63]
    ds_read_b128 v[84:87], v4 offset:27648
    v_cvt_pk_bf16_f32 v44, v56, v57
    v_mfma_f32_16x16x32_bf16 v[64:67], a[76:79], v[248:251], v[64:67]
    v_fmac_f32 v48, v88, v208
    v_fmac_f32 v49, v88, v209
    v_mfma_f32_16x16x32_bf16 v[68:71], a[80:83], v[248:251], v[68:71]
    v_fmac_f32 v50, v88, v210
    v_fmac_f32 v51, v88, v211
    v_mfma_f32_16x16x32_bf16 v[60:63], a[84:87], v[252:255], v[60:63]
    v_mul_f32 v28, v89, v48
    v_mul_f32 v29, v89, v49
    v_mfma_f32_16x16x32_bf16 v[64:67], a[88:91], v[252:255], v[64:67]
    v_mul_f32 v30, v89, v50
    v_mul_f32 v31, v89, v51
    v_mfma_f32_16x16x32_bf16 v[68:71], a[92:95], v[252:255], v[68:71]
    buffer_load_dwordx4 v[120:123], v23, s[36:39], s97 offen offset:2048 sc1
    v_fmac_f32 v52, v88, v212
    s_waitcnt lgkmcnt(0)
    v_mfma_f32_16x16x32_bf16 v[60:63], a[96:99], v[72:75], v[60:63]
    ds_read_b128 v[224:227], v4 offset:28672
    v_fmac_f32 v53, v88, v213
    v_mfma_f32_16x16x32_bf16 v[64:67], a[100:103], v[72:75], v[64:67]
    v_fmac_f32 v54, v88, v214
    v_fmac_f32 v55, v88, v215
    v_mfma_f32_16x16x32_bf16 v[68:71], a[104:107], v[72:75], v[68:71]
    ds_read_b128 v[228:231], v4 offset:29696
    v_mfma_f32_16x16x32_bf16 v[60:63], a[108:111], v[76:79], v[60:63]
    v_exp_f32 v28, v28
    v_mfma_f32_16x16x32_bf16 v[64:67], a[112:115], v[76:79], v[64:67]
    ds_read_b128 v[248:251], v4 offset:30720
    buffer_load_dwordx4 v[124:127], v23, s[36:39], s97 offen offset:3072 sc1
    v_mfma_f32_16x16x32_bf16 v[68:71], a[116:119], v[76:79], v[68:71]
    s_add_u32 s97, s16, 24576
    v_exp_f32 v29, v29
    v_mfma_f32_16x16x32_bf16 v[60:63], a[120:123], v[80:83], v[60:63]
    ds_read_b128 v[252:255], v4 offset:31744
    v_mfma_f32_16x16x32_bf16 v[64:67], a[124:127], v[80:83], v[64:67]
    v_exp_f32 v30, v30
    v_mfma_f32_16x16x32_bf16 v[68:71], a[128:131], v[80:83], v[68:71]
    v_exp_f32 v31, v31
    v_mul_f32 v48, v48, v52
    v_mfma_f32_16x16x32_bf16 v[60:63], a[132:135], v[84:87], v[60:63]
    v_mul_f32 v49, v49, v53
    v_mul_f32 v50, v50, v54
    v_mfma_f32_16x16x32_bf16 v[64:67], a[136:139], v[84:87], v[64:67]
    buffer_load_dwordx4 v[128:131], v23, s[36:39], s97 offen offset:0 sc1
    v_mul_f32 v51, v51, v55
    v_mfma_f32_16x16x32_bf16 v[68:71], a[140:143], v[84:87], v[68:71]
    v_fma_f32 v28, v28, v90, v90
    v_fma_f32 v29, v29, v90, v90
    s_waitcnt lgkmcnt(0)
    v_mfma_f32_16x16x32_bf16 v[60:63], a[144:147], v[224:227], v[60:63]
    ds_read_b128 v[72:75], v4 offset:32768
    v_fma_f32 v30, v30, v90, v90
    v_mfma_f32_16x16x32_bf16 v[64:67], a[148:151], v[224:227], v[64:67]
    ds_read_b128 v[36:39], v5 offset:5120
    v_fma_f32 v31, v31, v90, v90
    v_mfma_f32_16x16x32_bf16 v[68:71], a[152:155], v[224:227], v[68:71]
    ds_read_b128 v[76:79], v4 offset:33792
    v_mfma_f32_16x16x32_bf16 v[60:63], a[156:159], v[228:231], v[60:63]
    v_rcp_f32 v28, v28
    v_mfma_f32_16x16x32_bf16 v[64:67], a[160:163], v[228:231], v[64:67]
    ds_read_b128 v[80:83], v4 offset:34816
    buffer_load_dwordx4 v[132:135], v23, s[36:39], s97 offen offset:1024 sc1
    v_mfma_f32_16x16x32_bf16 v[68:71], a[164:167], v[228:231], v[68:71]
    v_rcp_f32 v29, v29
    v_mfma_f32_16x16x32_bf16 v[60:63], a[168:171], v[248:251], v[60:63]
    ds_read_b128 v[84:87], v4 offset:35840
    v_rcp_f32 v30, v30
    v_mfma_f32_16x16x32_bf16 v[64:67], a[172:175], v[248:251], v[64:67]
    v_rcp_f32 v31, v31
    v_mfma_f32_16x16x32_bf16 v[68:71], a[176:179], v[248:251], v[68:71]
    v_mul_f32 v48, v48, v28
    v_mul_f32 v49, v49, v29
    v_mfma_f32_16x16x32_bf16 v[60:63], a[180:183], v[252:255], v[60:63]
    v_mul_f32 v50, v50, v30
    v_mul_f32 v51, v51, v31
    v_mfma_f32_16x16x32_bf16 v[64:67], a[184:187], v[252:255], v[64:67]
    buffer_load_dwordx4 v[136:139], v23, s[36:39], s97 offen offset:2048 sc1
    v_cvt_pk_bf16_f32 v92, v48, v49
    v_mfma_f32_16x16x32_bf16 v[68:71], a[188:191], v[252:255], v[68:71]
    v_cvt_pk_bf16_f32 v93, v50, v51
    s_waitcnt vmcnt(8)
    s_waitcnt lgkmcnt(0)
    s_barrier
    v_mfma_f32_16x16x32_bf16 v[48:51], a[0:3], v[72:75], 0
    ds_read_b128 v[224:227], v4 offset:36864
    s_lshl_b32 s98, s46, 8
    v_mfma_f32_16x16x32_bf16 v[52:55], a[4:7], v[72:75], 0
    s_add_u32 s98, s98, 12288
    v_mfma_f32_16x16x32_bf16 v[56:59], a[8:11], v[72:75], 0
    ds_read_b128 v[228:231], v4 offset:37888
    v_mov_b32 v238, 1
    v_permlane16_swap_b32 v68, v70
    v_mfma_f32_16x16x32_bf16 v[48:51], a[12:15], v[76:79], v[48:51]
    buffer_atomic_add v238, v222, s[36:39], s98 offen sc1
    v_mfma_f32_16x16x32_bf16 v[52:55], a[16:19], v[76:79], v[52:55]
    ds_read_b128 v[248:251], v4 offset:38912
    buffer_load_dwordx4 v[140:143], v23, s[36:39], s97 offen offset:3072 sc1
    v_mfma_f32_16x16x32_bf16 v[56:59], a[20:23], v[76:79], v[56:59]
    s_add_u32 s97, s16, 28672
    v_permlane16_swap_b32 v69, v71
    v_mfma_f32_16x16x32_bf16 v[48:51], a[24:27], v[80:83], v[48:51]
    ds_read_b128 v[252:255], v4 offset:39936
    v_fmac_f32 v68, v36, v216
    v_fmac_f32 v69, v36, v217
    v_mfma_f32_16x16x32_bf16 v[52:55], a[28:31], v[80:83], v[52:55]
    v_mul_f32 v28, v37, v68
    v_mul_f32 v29, v37, v69
    v_mfma_f32_16x16x32_bf16 v[56:59], a[32:35], v[80:83], v[56:59]
    v_fmac_f32 v70, v36, v218
    v_fmac_f32 v71, v36, v219
    v_mfma_f32_16x16x32_bf16 v[48:51], a[36:39], v[84:87], v[48:51]
    buffer_load_dwordx4 v[144:147], v23, s[36:39], s97 offen offset:0 sc1
    v_mfma_f32_16x16x32_bf16 v[52:55], a[40:43], v[84:87], v[52:55]
    v_exp_f32 v28, v28
    v_exp_f32 v29, v29
    v_mfma_f32_16x16x32_bf16 v[56:59], a[44:47], v[84:87], v[56:59]
    v_mul_f32 v68, v68, v70
    v_mul_f32 v69, v69, v71
    s_waitcnt lgkmcnt(0)
    v_mfma_f32_16x16x32_bf16 v[48:51], a[48:51], v[224:227], v[48:51]
    ds_read_b128 v[72:75], v4 offset:40960
    v_fma_f32 v28, v28, v38, v38
    v_mfma_f32_16x16x32_bf16 v[52:55], a[52:55], v[224:227], v[52:55]
    v_fma_f32 v29, v29, v38, v38
    v_mfma_f32_16x16x32_bf16 v[56:59], a[56:59], v[224:227], v[56:59]
    ds_read_b128 v[76:79], v4 offset:41984
    v_rcp_f32 v28, v28
    v_mfma_f32_16x16x32_bf16 v[48:51], a[60:63], v[228:231], v[48:51]
    buffer_load_dwordx4 v[148:151], v23, s[36:39], s97 offen offset:1024 sc1
    v_rcp_f32 v29, v29
    v_mfma_f32_16x16x32_bf16 v[52:55], a[64:67], v[228:231], v[52:55]
    ds_read_b128 v[80:83], v4 offset:43008
    s_add_u32 s15, s15, 45056
    v_mfma_f32_16x16x32_bf16 v[56:59], a[68:71], v[228:231], v[56:59]
    v_mul_f32 v68, v68, v28
    v_mul_f32 v69, v69, v29
    v_mfma_f32_16x16x32_bf16 v[48:51], a[72:75], v[248:251], v[48:51]
    ds_read_b128 v[84:87], v4 offset:44032
    v_cvt_pk_bf16_f32 v45, v68, v69
    v_mfma_f32_16x16x32_bf16 v[52:55], a[76:79], v[248:251], v[52:55]
    s_nop 0
    v_permlane16_swap_b32 v44, v45
    buffer_store_dwordx2 v[44:45], v6, s[36:39], s15 offen sc1
    v_mfma_f32_16x16x32_bf16 v[56:59], a[80:83], v[248:251], v[56:59]
    v_fmac_f32 v60, v36, v208
    v_fmac_f32 v61, v36, v209
    v_mfma_f32_16x16x32_bf16 v[48:51], a[84:87], v[252:255], v[48:51]
    buffer_load_dwordx4 v[152:155], v23, s[36:39], s97 offen offset:2048 sc1
    v_fmac_f32 v62, v36, v210
    v_mfma_f32_16x16x32_bf16 v[52:55], a[88:91], v[252:255], v[52:55]
    v_fmac_f32 v63, v36, v211
    v_mul_f32 v28, v37, v60
    v_mul_f32 v29, v37, v61
    v_mfma_f32_16x16x32_bf16 v[56:59], a[92:95], v[252:255], v[56:59]
    v_mul_f32 v30, v37, v62
    v_mul_f32 v31, v37, v63
    s_waitcnt lgkmcnt(0)
    v_mfma_f32_16x16x32_bf16 v[48:51], a[96:99], v[72:75], v[48:51]
    ds_read_b128 v[224:227], v4 offset:45056
    v_fmac_f32 v64, v36, v212
    v_mfma_f32_16x16x32_bf16 v[52:55], a[100:103], v[72:75], v[52:55]
    v_fmac_f32 v65, v36, v213
    v_fmac_f32 v66, v36, v214
    v_mfma_f32_16x16x32_bf16 v[56:59], a[104:107], v[72:75], v[56:59]
    ds_read_b128 v[228:231], v4 offset:46080
    v_fmac_f32 v67, v36, v215
    v_mfma_f32_16x16x32_bf16 v[48:51], a[108:111], v[76:79], v[48:51]
    buffer_load_dwordx4 v[156:159], v23, s[36:39], s97 offen offset:3072 sc1
    s_add_u32 s97, s16, 32768
    v_mfma_f32_16x16x32_bf16 v[52:55], a[112:115], v[76:79], v[52:55]
    ds_read_b128 v[248:251], v4 offset:47104
    v_exp_f32 v28, v28
    v_mfma_f32_16x16x32_bf16 v[56:59], a[116:119], v[76:79], v[56:59]
    v_exp_f32 v29, v29
    v_mfma_f32_16x16x32_bf16 v[48:51], a[120:123], v[80:83], v[48:51]
    ds_read_b128 v[252:255], v4 offset:48128
    v_exp_f32 v30, v30
    v_mfma_f32_16x16x32_bf16 v[52:55], a[124:127], v[80:83], v[52:55]
    v_exp_f32 v31, v31
    v_mfma_f32_16x16x32_bf16 v[56:59], a[128:131], v[80:83], v[56:59]
    buffer_load_dwordx4 v[160:163], v23, s[36:39], s97 offen offset:0 sc1
    v_mul_f32 v60, v60, v64
    v_mfma_f32_16x16x32_bf16 v[48:51], a[132:135], v[84:87], v[48:51]
    v_mul_f32 v61, v61, v65
    v_mul_f32 v62, v62, v66
    v_mfma_f32_16x16x32_bf16 v[52:55], a[136:139], v[84:87], v[52:55]
    v_mul_f32 v63, v63, v67
    v_fma_f32 v28, v28, v38, v38
    v_fma_f32 v29, v29, v38, v38
    v_mfma_f32_16x16x32_bf16 v[56:59], a[140:143], v[84:87], v[56:59]
    v_fma_f32 v30, v30, v38, v38
    v_fma_f32 v31, v31, v38, v38
    s_waitcnt lgkmcnt(0)
    v_mfma_f32_16x16x32_bf16 v[48:51], a[144:147], v[224:227], v[48:51]
    ds_read_b128 v[72:75], v4 offset:49152
    v_mfma_f32_16x16x32_bf16 v[52:55], a[148:151], v[224:227], v[52:55]
    ds_read_b128 v[88:91], v5 offset:6144
    v_rcp_f32 v28, v28
    v_mfma_f32_16x16x32_bf16 v[56:59], a[152:155], v[224:227], v[56:59]
    ds_read_b128 v[76:79], v4 offset:50176
    buffer_load_dwordx4 v[164:167], v23, s[36:39], s97 offen offset:1024 sc1
    v_mfma_f32_16x16x32_bf16 v[48:51], a[156:159], v[228:231], v[48:51]
    v_rcp_f32 v29, v29
    v_mfma_f32_16x16x32_bf16 v[52:55], a[160:163], v[228:231], v[52:55]
    ds_read_b128 v[80:83], v4 offset:51200
    v_rcp_f32 v30, v30
    v_mfma_f32_16x16x32_bf16 v[56:59], a[164:167], v[228:231], v[56:59]
    v_rcp_f32 v31, v31
    v_mfma_f32_16x16x32_bf16 v[48:51], a[168:171], v[248:251], v[48:51]
    ds_read_b128 v[84:87], v4 offset:52224
    s_add_u32 s4, s4, 45056
    v_mul_f32 v60, v60, v28
    v_mfma_f32_16x16x32_bf16 v[52:55], a[172:175], v[248:251], v[52:55]
    v_mul_f32 v61, v61, v29
    v_mul_f32 v62, v62, v30
    v_mfma_f32_16x16x32_bf16 v[56:59], a[176:179], v[248:251], v[56:59]
    buffer_load_dwordx4 v[168:171], v23, s[36:39], s97 offen offset:2048 sc1
    v_mul_f32 v63, v63, v31
    v_mfma_f32_16x16x32_bf16 v[48:51], a[180:183], v[252:255], v[48:51]
    v_cvt_pk_bf16_f32 v94, v60, v61
    v_cvt_pk_bf16_f32 v95, v62, v63
    v_mfma_f32_16x16x32_bf16 v[52:55], a[184:187], v[252:255], v[52:55]
    v_permlane16_swap_b32 v92, v94
    v_mfma_f32_16x16x32_bf16 v[56:59], a[188:191], v[252:255], v[56:59]
    v_permlane16_swap_b32 v93, v95
    buffer_store_dwordx4 v[92:95], v20, s[36:39], s4 offen sc1
    s_waitcnt lgkmcnt(0)
    v_mfma_f32_16x16x32_bf16 v[60:63], a[0:3], v[72:75], 0
    ds_read_b128 v[224:227], v4 offset:53248
    v_mfma_f32_16x16x32_bf16 v[64:67], a[4:7], v[72:75], 0
    s_nop 1
    v_permlane16_swap_b32 v56, v58
    v_mfma_f32_16x16x32_bf16 v[68:71], a[8:11], v[72:75], 0
    ds_read_b128 v[228:231], v4 offset:54272
    buffer_load_dwordx4 v[172:175], v23, s[36:39], s97 offen offset:3072 sc1
    v_mfma_f32_16x16x32_bf16 v[60:63], a[12:15], v[76:79], v[60:63]
    v_permlane16_swap_b32 v57, v59
    v_mfma_f32_16x16x32_bf16 v[64:67], a[16:19], v[76:79], v[64:67]
    ds_read_b128 v[248:251], v4 offset:55296
    v_fmac_f32 v56, v88, v216
    v_mfma_f32_16x16x32_bf16 v[68:71], a[20:23], v[76:79], v[68:71]
    v_fmac_f32 v57, v88, v217
    v_mul_f32 v28, v89, v56
    v_mfma_f32_16x16x32_bf16 v[60:63], a[24:27], v[80:83], v[60:63]
    ds_read_b128 v[252:255], v4 offset:56320
    v_mul_f32 v29, v89, v57
    v_mfma_f32_16x16x32_bf16 v[64:67], a[28:31], v[80:83], v[64:67]
    v_fmac_f32 v58, v88, v218
    v_fmac_f32 v59, v88, v219
    v_mfma_f32_16x16x32_bf16 v[68:71], a[32:35], v[80:83], v[68:71]
    v_mov_b32 v238, 0
    buffer_atomic_or v238, v222, s[36:39], s8 offen sc0 sc1
    v_mfma_f32_16x16x32_bf16 v[60:63], a[36:39], v[84:87], v[60:63]
    s_add_u32 s97, s16, 36864
    v_mfma_f32_16x16x32_bf16 v[64:67], a[40:43], v[84:87], v[64:67]
    v_exp_f32 v28, v28
    v_mfma_f32_16x16x32_bf16 v[68:71], a[44:47], v[84:87], v[68:71]
    v_exp_f32 v29, v29
    v_mul_f32 v56, v56, v58
    s_waitcnt lgkmcnt(0)
    v_mfma_f32_16x16x32_bf16 v[60:63], a[48:51], v[224:227], v[60:63]
    ds_read_b128 v[72:75], v4 offset:57344
    buffer_load_dwordx4 v[176:179], v23, s[36:39], s97 offen offset:0 sc1
    v_mfma_f32_16x16x32_bf16 v[64:67], a[52:55], v[224:227], v[64:67]
    v_mul_f32 v57, v57, v59
    v_fma_f32 v28, v28, v90, v90
    v_mfma_f32_16x16x32_bf16 v[68:71], a[56:59], v[224:227], v[68:71]
    ds_read_b128 v[76:79], v4 offset:58368
    v_mfma_f32_16x16x32_bf16 v[60:63], a[60:63], v[228:231], v[60:63]
    v_fma_f32 v29, v29, v90, v90
    v_mfma_f32_16x16x32_bf16 v[64:67], a[64:67], v[228:231], v[64:67]
    ds_read_b128 v[80:83], v4 offset:59392
    buffer_load_dwordx4 v[180:183], v23, s[36:39], s97 offen offset:1024 sc1
    v_mfma_f32_16x16x32_bf16 v[68:71], a[68:71], v[228:231], v[68:71]
    v_rcp_f32 v28, v28
    v_mfma_f32_16x16x32_bf16 v[60:63], a[72:75], v[248:251], v[60:63]
    ds_read_b128 v[84:87], v4 offset:60416
    v_rcp_f32 v29, v29
    v_mfma_f32_16x16x32_bf16 v[64:67], a[76:79], v[248:251], v[64:67]
    v_mul_f32 v56, v56, v28
    v_mul_f32 v57, v57, v29
    v_mfma_f32_16x16x32_bf16 v[68:71], a[80:83], v[248:251], v[68:71]
    v_cvt_pk_bf16_f32 v44, v56, v57
    v_fmac_f32 v48, v88, v208
    v_mfma_f32_16x16x32_bf16 v[60:63], a[84:87], v[252:255], v[60:63]
    buffer_load_dwordx4 v[184:187], v23, s[36:39], s97 offen offset:2048 sc1
    v_fmac_f32 v49, v88, v209
    v_mfma_f32_16x16x32_bf16 v[64:67], a[88:91], v[252:255], v[64:67]
    v_fmac_f32 v50, v88, v210
    v_fmac_f32 v51, v88, v211
    v_mfma_f32_16x16x32_bf16 v[68:71], a[92:95], v[252:255], v[68:71]
    v_mul_f32 v28, v89, v48
    v_mul_f32 v29, v89, v49
    s_waitcnt lgkmcnt(0)
    v_mfma_f32_16x16x32_bf16 v[60:63], a[96:99], v[72:75], v[60:63]
    ds_read_b128 v[224:227], v4 offset:61440
    v_mul_f32 v30, v89, v50
    v_mfma_f32_16x16x32_bf16 v[64:67], a[100:103], v[72:75], v[64:67]
    buffer_load_dwordx4 v[188:191], v23, s[36:39], s97 offen offset:3072 sc1
    s_add_u32 s97, s16, 40960
    v_mfma_f32_16x16x32_bf16 v[68:71], a[104:107], v[72:75], v[68:71]
    ds_read_b128 v[228:231], v4 offset:62464
    v_mul_f32 v31, v89, v51
    v_mfma_f32_16x16x32_bf16 v[60:63], a[108:111], v[76:79], v[60:63]
    v_fmac_f32 v52, v88, v212
    v_fmac_f32 v53, v88, v213
    v_mfma_f32_16x16x32_bf16 v[64:67], a[112:115], v[76:79], v[64:67]
    ds_read_b128 v[248:251], v4 offset:63488
    v_fmac_f32 v54, v88, v214
    v_mfma_f32_16x16x32_bf16 v[68:71], a[116:119], v[76:79], v[68:71]
    v_fmac_f32 v55, v88, v215
    v_mfma_f32_16x16x32_bf16 v[60:63], a[120:123], v[80:83], v[60:63]
    ds_read_b128 v[252:255], v4 offset:64512
    buffer_load_dwordx4 v[192:195], v23, s[36:39], s97 offen offset:0 sc1
    v_mfma_f32_16x16x32_bf16 v[64:67], a[124:127], v[80:83], v[64:67]
    v_exp_f32 v28, v28
    v_mfma_f32_16x16x32_bf16 v[68:71], a[128:131], v[80:83], v[68:71]
    v_exp_f32 v29, v29
    v_mfma_f32_16x16x32_bf16 v[60:63], a[132:135], v[84:87], v[60:63]
    v_exp_f32 v30, v30
    v_mfma_f32_16x16x32_bf16 v[64:67], a[136:139], v[84:87], v[64:67]
    buffer_load_dwordx4 v[196:199], v23, s[36:39], s97 offen offset:1024 sc1
    v_exp_f32 v31, v31
    v_mfma_f32_16x16x32_bf16 v[68:71], a[140:143], v[84:87], v[68:71]
    v_mul_f32 v48, v48, v52
    v_mul_f32 v49, v49, v53
    s_waitcnt lgkmcnt(0)
    v_mfma_f32_16x16x32_bf16 v[60:63], a[144:147], v[224:227], v[60:63]
    v_mul_f32 v50, v50, v54
    v_mul_f32 v51, v51, v55
    v_mfma_f32_16x16x32_bf16 v[64:67], a[148:151], v[224:227], v[64:67]
    ds_read_b128 v[36:39], v5 offset:7168
    v_fma_f32 v28, v28, v90, v90
    v_mfma_f32_16x16x32_bf16 v[68:71], a[152:155], v[224:227], v[68:71]
    v_fma_f32 v29, v29, v90, v90
    v_mfma_f32_16x16x32_bf16 v[60:63], a[156:159], v[228:231], v[60:63]
    buffer_load_dwordx4 v[200:203], v23, s[36:39], s97 offen offset:2048 sc1
    v_fma_f32 v30, v30, v90, v90
    v_mfma_f32_16x16x32_bf16 v[64:67], a[160:163], v[228:231], v[64:67]
    v_fma_f32 v31, v31, v90, v90
    v_mfma_f32_16x16x32_bf16 v[68:71], a[164:167], v[228:231], v[68:71]
    v_rcp_f32 v28, v28
    v_mfma_f32_16x16x32_bf16 v[60:63], a[168:171], v[248:251], v[60:63]
    v_rcp_f32 v29, v29
    v_mfma_f32_16x16x32_bf16 v[64:67], a[172:175], v[248:251], v[64:67]
    buffer_load_dwordx4 v[204:207], v23, s[36:39], s97 offen offset:3072 sc1
    v_rcp_f32 v30, v30
    v_mfma_f32_16x16x32_bf16 v[68:71], a[176:179], v[248:251], v[68:71]
    v_rcp_f32 v31, v31
    v_mfma_f32_16x16x32_bf16 v[60:63], a[180:183], v[252:255], v[60:63]
    v_mul_f32 v48, v48, v28
    v_mul_f32 v49, v49, v29
    v_mfma_f32_16x16x32_bf16 v[64:67], a[184:187], v[252:255], v[64:67]
    v_mul_f32 v50, v50, v30
    v_mul_f32 v51, v51, v31
    v_mfma_f32_16x16x32_bf16 v[68:71], a[188:191], v[252:255], v[68:71]
    v_cvt_pk_bf16_f32 v92, v48, v49
    v_cvt_pk_bf16_f32 v93, v50, v51
    s_waitcnt lgkmcnt(0)
    s_waitcnt vmcnt(10)
    s_waitcnt vmcnt(8)
    v_readfirstlane_b32 s62, v238
    s_nop 1
    s_sub_u32 s62, s62, s49
    s_xor_b32 s62, s62, 16
    s_and_b32 s62, s62, s101
    s_cbranch_scc1 L_cold30
L_cold30_r:
    s_barrier
    s_lshl_b32 s98, s46, 8
    s_add_u32 s98, s98, 16384
    v_mov_b32 v8, 1
    buffer_atomic_add v8, v222, s[36:39], s98 offen sc1
    s_lshl4_add_u32 s54, s44, s48
    s_mul_i32 s54, s54, 11264
    s_add_u32 s3, s54, 9306112
    s_cmp_eq_u32 s48, 3
    s_cselect_b32 s55, 2130706432, 0
    v_add_u32 v11, s55, v23
    v_permlane16_swap_b32 v68, v70
    v_permlane16_swap_b32 v69, v71
    v_fmac_f32 v68, v36, v216
    s_add_u32 s96, s3, 0
    buffer_load_dwordx4 a[0:3], v23, s[36:39], s96 offen offset:0 sc1
    v_fmac_f32 v69, v36, v217
    v_mul_f32 v28, v37, v68
    v_mul_f32 v29, v37, v69
    s_branch L_pgo6
L_pg6:
    s_branch L_pgback5
L_pgo6:
    v_fmac_f32 v70, v36, v218
    v_fmac_f32 v71, v36, v219
    v_exp_f32 v28, v28
    v_exp_f32 v29, v29
    v_mul_f32 v68, v68, v70
    v_mul_f32 v69, v69, v71
    v_fma_f32 v28, v28, v38, v38
    v_fma_f32 v29, v29, v38, v38
    v_rcp_f32 v28, v28
    v_rcp_f32 v29, v29
    buffer_load_dwordx4 a[4:7], v23, s[36:39], s96 offen offset:1024 sc1
    s_add_u32 s15, s15, 45056
    v_mul_f32 v68, v68, v28
    v_mul_f32 v69, v69, v29
    v_cvt_pk_bf16_f32 v45, v68, v69
    s_nop 1
    v_permlane16_swap_b32 v44, v45
    buffer_store_dwordx2 v[44:45], v6, s[36:39], s15 offen sc1
    v_fmac_f32 v60, v36, v208
    v_fmac_f32 v61, v36, v209
    v_fmac_f32 v62, v36, v210
    v_fmac_f32 v63, v36, v211
    v_mul_f32 v28, v37, v60
    v_mul_f32 v29, v37, v61
    v_mul_f32 v30, v37, v62
    buffer_load_dwordx4 a[8:11], v23, s[36:39], s96 offen offset:2048 sc1
    v_mul_f32 v31, v37, v63
    v_fmac_f32 v64, v36, v212
    v_fmac_f32 v65, v36, v213
    v_fmac_f32 v66, v36, v214
    v_fmac_f32 v67, v36, v215
    v_exp_f32 v28, v28
    v_exp_f32 v29, v29
    v_exp_f32 v30, v30
    v_exp_f32 v31, v31
    v_mul_f32 v60, v60, v64
    v_mul_f32 v61, v61, v65
    buffer_load_dwordx4 a[12:15], v23, s[36:39], s96 offen offset:3072 sc1
    v_mul_f32 v62, v62, v66
    v_mul_f32 v63, v63, v67
    v_fma_f32 v28, v28, v38, v38
    v_fma_f32 v29, v29, v38, v38
    v_fma_f32 v30, v30, v38, v38
    v_fma_f32 v31, v31, v38, v38
    v_rcp_f32 v28, v28
    v_rcp_f32 v29, v29
    v_rcp_f32 v30, v30
    v_rcp_f32 v31, v31
    s_add_u32 s4, s4, 45056
    v_mul_f32 v60, v60, v28
    s_add_u32 s96, s3, 4096
    buffer_load_dwordx4 a[16:19], v23, s[36:39], s96 offen offset:0 sc1
    v_mul_f32 v61, v61, v29
    v_mul_f32 v62, v62, v30
    v_mul_f32 v63, v63, v31
    v_cvt_pk_bf16_f32 v94, v60, v61
    v_cvt_pk_bf16_f32 v95, v62, v63
    s_nop 0
    v_permlane16_swap_b32 v92, v94
    v_permlane16_swap_b32 v93, v95
    buffer_store_dwordx4 v[92:95], v20, s[36:39], s4 offen sc1
    v_and_b32 v8, 7, v1
    buffer_load_dwordx4 a[20:23], v23, s[36:39], s96 offen offset:1024 sc1
    v_xor_b32 v8, v8, v2
    v_lshlrev_b32 v8, 4, v8
    v_lshl_or_b32 v8, v3, 8, v8
    buffer_load_dwordx4 a[24:27], v23, s[36:39], s96 offen offset:2048 sc1
    s_lshl_b32 s54, s48, 13
    v_add_u32 v12, s54, v8
    buffer_load_dwordx4 a[28:31], v23, s[36:39], s96 offen offset:3072 sc1
    v_xor_b32 v13, 64, v12
    v_xor_b32 v15, 16, v235
    s_mov_b32 s54, 32768
    s_add_u32 s96, s3, 8192
    buffer_load_dwordx4 a[32:35], v23, s[36:39], s96 offen offset:0 sc1
    s_lshl_b32 s18, s27, 8
    s_add_u32 s18, s18, 16384
    s_lshl_b32 s19, s27, 8
    buffer_load_dwordx4 a[36:39], v23, s[36:39], s96 offen offset:1024 sc1
    s_add_u32 s19, s19, 20480
    s_waitcnt vmcnt(11)
    v_mfma_f32_16x16x32_bf16 v[28:31], a[192:195], a[0:3], 0
    buffer_load_dwordx4 a[40:43], v11, s[36:39], s96 offen offset:2048 sc1
    v_mfma_f32_16x16x32_bf16 v[32:35], a[196:199], a[0:3], 0
    v_mfma_f32_16x16x32_bf16 v[36:39], a[200:203], a[0:3], 0
    v_mfma_f32_16x16x32_bf16 v[40:43], a[204:207], a[0:3], 0
    s_waitcnt vmcnt(11)
    v_mfma_f32_16x16x32_bf16 v[28:31], a[208:211], a[4:7], v[28:31]
    s_add_u32 s96, s3, 45056
    buffer_load_dwordx4 a[44:47], v23, s[36:39], s96 offen offset:0 sc1
    v_mfma_f32_16x16x32_bf16 v[32:35], a[212:215], a[4:7], v[32:35]
    v_mfma_f32_16x16x32_bf16 v[36:39], a[216:219], a[4:7], v[36:39]
    v_mfma_f32_16x16x32_bf16 v[40:43], a[220:223], a[4:7], v[40:43]
    s_waitcnt vmcnt(10)
    v_mfma_f32_16x16x32_bf16 v[28:31], a[224:227], a[8:11], v[28:31]
    buffer_load_dwordx4 a[48:51], v23, s[36:39], s96 offen offset:1024 sc1
    v_mfma_f32_16x16x32_bf16 v[32:35], a[228:231], a[8:11], v[32:35]
    v_mfma_f32_16x16x32_bf16 v[36:39], a[232:235], a[8:11], v[36:39]
    v_mfma_f32_16x16x32_bf16 v[40:43], a[236:239], a[8:11], v[40:43]
    s_waitcnt vmcnt(10)
    v_mfma_f32_16x16x32_bf16 v[28:31], a[240:243], a[12:15], v[28:31]
    buffer_load_dwordx4 a[52:55], v23, s[36:39], s96 offen offset:2048 sc1
    s_cmp_lg_u32 s48, 0
    s_cbranch_scc1 L_lk33
    s_mov_b32 s62, 0
    s_atomic_or s62, s[36:37], s18 glc
L_lk33:
    v_mfma_f32_16x16x32_bf16 v[32:35], a[244:247], a[12:15], v[32:35]
    v_mfma_f32_16x16x32_bf16 v[36:39], a[248:251], a[12:15], v[36:39]
    v_mfma_f32_16x16x32_bf16 v[40:43], a[252:255], a[12:15], v[40:43]
    s_waitcnt vmcnt(10)
    v_mfma_f32_16x16x32_bf16 v[28:31], v[96:99], a[16:19], v[28:31]
    buffer_load_dwordx4 a[56:59], v23, s[36:39], s96 offen offset:3072 sc1
    v_mfma_f32_16x16x32_bf16 v[32:35], v[100:103], a[16:19], v[32:35]
    v_mfma_f32_16x16x32_bf16 v[36:39], v[104:107], a[16:19], v[36:39]
    v_mfma_f32_16x16x32_bf16 v[40:43], v[108:111], a[16:19], v[40:43]
    s_waitcnt vmcnt(10)
    s_barrier
    s_cmp_lg_u32 s48, 3
    s_cbranch_scc1 L_skip34
    s_lshl_b32 s59, s46, 8
    s_add_u32 s59, s59, 20480
    s_atomic_add s5, s[36:37], s59
L_skip34:
    s_waitcnt vmcnt(9)
    v_mfma_f32_16x16x32_bf16 v[28:31], v[112:115], a[20:23], v[28:31]
    s_add_u32 s96, s3, 49152
    buffer_load_dwordx4 a[60:63], v23, s[36:39], s96 offen offset:0 sc1
    v_mfma_f32_16x16x32_bf16 v[32:35], v[116:119], a[20:23], v[32:35]
    v_mfma_f32_16x16x32_bf16 v[36:39], v[120:123], a[20:23], v[36:39]
    v_mfma_f32_16x16x32_bf16 v[40:43], v[124:127], a[20:23], v[40:43]
    s_waitcnt vmcnt(9)
    v_mfma_f32_16x16x32_bf16 v[28:31], v[128:131], a[24:27], v[28:31]
    buffer_load_dwordx4 a[64:67], v23, s[36:39], s96 offen offset:1024 sc1
    v_mfma_f32_16x16x32_bf16 v[32:35], v[132:135], a[24:27], v[32:35]
    v_mfma_f32_16x16x32_bf16 v[36:39], v[136:139], a[24:27], v[36:39]
    v_mfma_f32_16x16x32_bf16 v[40:43], v[140:143], a[24:27], v[40:43]
    s_waitcnt vmcnt(9)
    v_mfma_f32_16x16x32_bf16 v[28:31], v[144:147], a[28:31], v[28:31]
    buffer_load_dwordx4 a[68:71], v23, s[36:39], s96 offen offset:2048 sc1
    v_mfma_f32_16x16x32_bf16 v[32:35], v[148:151], a[28:31], v[32:35]
    v_mfma_f32_16x16x32_bf16 v[36:39], v[152:155], a[28:31], v[36:39]
    v_mfma_f32_16x16x32_bf16 v[40:43], v[156:159], a[28:31], v[40:43]
    s_waitcnt vmcnt(9)
    v_mfma_f32_16x16x32_bf16 v[28:31], v[160:163], a[32:35], v[28:31]
    buffer_load_dwordx4 a[72:75], v23, s[36:39], s96 offen offset:3072 sc1
    v_mfma_f32_16x16x32_bf16 v[32:35], v[164:167], a[32:35], v[32:35]
    v_mfma_f32_16x16x32_bf16 v[36:39], v[168:171], a[32:35], v[36:39]
    v_mfma_f32_16x16x32_bf16 v[40:43], v[172:175], a[32:35], v[40:43]
    s_waitcnt vmcnt(9)
    v_mfma_f32_16x16x32_bf16 v[28:31], v[176:179], a[36:39], v[28:31]
    s_add_u32 s96, s3, 53248
    buffer_load_dwordx4 a[76:79], v23, s[36:39], s96 offen offset:0 sc1
    v_mfma_f32_16x16x32_bf16 v[32:35], v[180:183], a[36:39], v[32:35]
    v_mfma_f32_16x16x32_bf16 v[36:39], v[184:187], a[36:39], v[36:39]
    v_mfma_f32_16x16x32_bf16 v[40:43], v[188:191], a[36:39], v[40:43]
    s_waitcnt vmcnt(9)
    v_mfma_f32_16x16x32_bf16 v[28:31], v[192:195], a[40:43], v[28:31]
    buffer_load_dwordx4 a[80:83], v23, s[36:39], s96 offen offset:1024 sc1
    v_mfma_f32_16x16x32_bf16 v[32:35], v[196:199], a[40:43], v[32:35]
    v_mfma_f32_16x16x32_bf16 v[36:39], v[200:203], a[40:43], v[36:39]
    v_mfma_f32_16x16x32_bf16 v[40:43], v[204:207], a[40:43], v[40:43]
    s_waitcnt vmcnt(9)
    v_mfma_f32_16x16x32_bf16 v[44:47], a[192:195], a[44:47], 0
    buffer_load_dwordx4 a[84:87], v11, s[36:39], s96 offen offset:2048 sc1
    v_mfma_f32_16x16x32_bf16 v[48:51], a[196:199], a[44:47], 0
    v_mfma_f32_16x16x32_bf16 v[52:55], a[200:203], a[44:47], 0
    v_mfma_f32_16x16x32_bf16 v[56:59], a[204:207], a[44:47], 0
    s_waitcnt vmcnt(9)
    v_mfma_f32_16x16x32_bf16 v[44:47], a[208:211], a[48:51], v[44:47]
    s_waitcnt lgkmcnt(0)
    s_sub_u32 s62, s62, s49
    s_xor_b32 s62, s62, 16
    s_and_b32 s62, s62, s101
    s_cbranch_scc1 L_cold35
L_cold35_r:
    s_barrier
    s_add_u32 s96, s3, 90112
    buffer_load_dwordx4 a[88:91], v23, s[36:39], s96 offen offset:0 sc1
    v_mfma_f32_16x16x32_bf16 v[48:51], a[212:215], a[48:51], v[48:51]
    v_mfma_f32_16x16x32_bf16 v[52:55], a[216:219], a[48:51], v[52:55]
    ds_write_b128 v12, v[28:31] offset:0
    v_mfma_f32_16x16x32_bf16 v[56:59], a[220:223], a[48:51], v[56:59]
    s_waitcnt vmcnt(9)
    v_mfma_f32_16x16x32_bf16 v[44:47], a[224:227], a[52:55], v[44:47]
    buffer_load_dwordx4 a[92:95], v23, s[36:39], s96 offen offset:1024 sc1
    v_mfma_f32_16x16x32_bf16 v[48:51], a[228:231], a[52:55], v[48:51]
    v_mfma_f32_16x16x32_bf16 v[52:55], a[232:235], a[52:55], v[52:55]
    ds_write_b128 v13, v[32:35] offset:0
    v_mfma_f32_16x16x32_bf16 v[56:59], a[236:239], a[52:55], v[56:59]
    s_waitcnt vmcnt(9)
    v_mfma_f32_16x16x32_bf16 v[44:47], a[240:243], a[56:59], v[44:47]
    buffer_load_dwordx4 a[96:99], v23, s[36:39], s96 offen offset:2048 sc1
    v_mfma_f32_16x16x32_bf16 v[48:51], a[244:247], a[56:59], v[48:51]
    v_mfma_f32_16x16x32_bf16 v[52:55], a[248:251], a[56:59], v[52:55]
    ds_write_b128 v12, v[36:39] offset:128
    v_mfma_f32_16x16x32_bf16 v[56:59], a[252:255], a[56:59], v[56:59]
    s_waitcnt vmcnt(9)
    v_mfma_f32_16x16x32_bf16 v[44:47], v[96:99], a[60:63], v[44:47]
    buffer_load_dwordx4 a[100:103], v23, s[36:39], s96 offen offset:3072 sc1
    s_cmp_lg_u32 s48, 0
    s_cbranch_scc1 L_lk38
    s_mov_b32 s62, 0
    s_atomic_or s62, s[36:37], s19 glc
L_lk38:
    v_mfma_f32_16x16x32_bf16 v[48:51], v[100:103], a[60:63], v[48:51]
    v_mfma_f32_16x16x32_bf16 v[52:55], v[104:107], a[60:63], v[52:55]
    ds_write_b128 v13, v[40:43] offset:128
    v_mfma_f32_16x16x32_bf16 v[56:59], v[108:111], a[60:63], v[56:59]
    s_waitcnt vmcnt(9)
    v_mfma_f32_16x16x32_bf16 v[44:47], v[112:115], a[64:67], v[44:47]
    s_add_u32 s96, s3, 94208
    buffer_load_dwordx4 a[104:107], v23, s[36:39], s96 offen offset:0 sc1
    v_mfma_f32_16x16x32_bf16 v[48:51], v[116:119], a[64:67], v[48:51]
    v_mfma_f32_16x16x32_bf16 v[52:55], v[120:123], a[64:67], v[52:55]
    v_mfma_f32_16x16x32_bf16 v[56:59], v[124:127], a[64:67], v[56:59]
    s_waitcnt vmcnt(9)
    v_mfma_f32_16x16x32_bf16 v[44:47], v[128:131], a[68:71], v[44:47]
    buffer_load_dwordx4 a[108:111], v23, s[36:39], s96 offen offset:1024 sc1
    v_mfma_f32_16x16x32_bf16 v[48:51], v[132:135], a[68:71], v[48:51]
    v_mfma_f32_16x16x32_bf16 v[52:55], v[136:139], a[68:71], v[52:55]
    v_mfma_f32_16x16x32_bf16 v[56:59], v[140:143], a[68:71], v[56:59]
    s_waitcnt vmcnt(9)
    v_mfma_f32_16x16x32_bf16 v[44:47], v[144:147], a[72:75], v[44:47]
    buffer_load_dwordx4 a[112:115], v23, s[36:39], s96 offen offset:2048 sc1
    v_mfma_f32_16x16x32_bf16 v[48:51], v[148:151], a[72:75], v[48:51]
    v_mfma_f32_16x16x32_bf16 v[52:55], v[152:155], a[72:75], v[52:55]
    v_mfma_f32_16x16x32_bf16 v[56:59], v[156:159], a[72:75], v[56:59]
    s_waitcnt vmcnt(9)
    v_mfma_f32_16x16x32_bf16 v[44:47], v[160:163], a[76:79], v[44:47]
    buffer_load_dwordx4 a[116:119], v23, s[36:39], s96 offen offset:3072 sc1
    v_mfma_f32_16x16x32_bf16 v[48:51], v[164:167], a[76:79], v[48:51]
    v_mfma_f32_16x16x32_bf16 v[52:55], v[168:171], a[76:79], v[52:55]
    v_mfma_f32_16x16x32_bf16 v[56:59], v[172:175], a[76:79], v[56:59]
    s_waitcnt vmcnt(9)
    v_mfma_f32_16x16x32_bf16 v[44:47], v[176:179], a[80:83], v[44:47]
    s_add_u32 s96, s3, 98304
    buffer_load_dwordx4 a[120:123], v23, s[36:39], s96 offen offset:0 sc1
    v_mfma_f32_16x16x32_bf16 v[48:51], v[180:183], a[80:83], v[48:51]
    v_mfma_f32_16x16x32_bf16 v[52:55], v[184:187], a[80:83], v[52:55]
    v_mfma_f32_16x16x32_bf16 v[56:59], v[188:191], a[80:83], v[56:59]
    s_waitcnt vmcnt(9)
    v_mfma_f32_16x16x32_bf16 v[44:47], v[192:195], a[84:87], v[44:47]
    buffer_load_dwordx4 a[124:127], v23, s[36:39], s96 offen offset:1024 sc1
    v_mfma_f32_16x16x32_bf16 v[48:51], v[196:199], a[84:87], v[48:51]
    v_mfma_f32_16x16x32_bf16 v[52:55], v[200:203], a[84:87], v[52:55]
    v_mfma_f32_16x16x32_bf16 v[56:59], v[204:207], a[84:87], v[56:59]
    s_waitcnt vmcnt(9)
    v_mfma_f32_16x16x32_bf16 v[28:31], a[192:195], a[88:91], 0
    buffer_load_dwordx4 a[128:131], v11, s[36:39], s96 offen offset:2048 sc1
    v_mfma_f32_16x16x32_bf16 v[32:35], a[196:199], a[88:91], 0
    v_mfma_f32_16x16x32_bf16 v[36:39], a[200:203], a[88:91], 0
    v_mfma_f32_16x16x32_bf16 v[40:43], a[204:207], a[88:91], 0
    s_waitcnt vmcnt(9)
    v_mfma_f32_16x16x32_bf16 v[28:31], a[208:211], a[92:95], v[28:31]
    s_waitcnt lgkmcnt(0)
    s_sub_u32 s62, s62, s49
    s_xor_b32 s62, s62, 16
    s_and_b32 s62, s62, s101
    s_cbranch_scc1 L_cold39
L_cold39_r:
    s_barrier
    s_add_u32 s96, s3, 135168
    buffer_load_dwordx4 a[132:135], v23, s[36:39], s96 offen offset:0 sc1
    v_mfma_f32_16x16x32_bf16 v[32:35], a[212:215], a[92:95], v[32:35]
    v_mfma_f32_16x16x32_bf16 v[36:39], a[216:219], a[92:95], v[36:39]
    ds_write_b128 v12, v[44:47] offset:4096
    v_mfma_f32_16x16x32_bf16 v[40:43], a[220:223], a[92:95], v[40:43]
    s_waitcnt vmcnt(9)
    v_mfma_f32_16x16x32_bf16 v[28:31], a[224:227], a[96:99], v[28:31]
    buffer_load_dwordx4 a[136:139], v23, s[36:39], s96 offen offset:1024 sc1
    v_mfma_f32_16x16x32_bf16 v[32:35], a[228:231], a[96:99], v[32:35]
    v_mfma_f32_16x16x32_bf16 v[36:39], a[232:235], a[96:99], v[36:39]
    ds_write_b128 v13, v[48:51] offset:4096
    v_mfma_f32_16x16x32_bf16 v[40:43], a[236:239], a[96:99], v[40:43]
    s_waitcnt vmcnt(9)
    v_mfma_f32_16x16x32_bf16 v[28:31], a[240:243], a[100:103], v[28:31]
    buffer_load_dwordx4 a[140:143], v23, s[36:39], s96 offen offset:2048 sc1
    v_mfma_f32_16x16x32_bf16 v[32:35], a[244:247], a[100:103], v[32:35]
    v_mfma_f32_16x16x32_bf16 v[36:39], a[248:251], a[100:103], v[36:39]
    ds_write_b128 v12, v[52:55] offset:4224
    v_mfma_f32_16x16x32_bf16 v[40:43], a[252:255], a[100:103], v[40:43]
    s_waitcnt vmcnt(9)
    v_mfma_f32_16x16x32_bf16 v[28:31], v[96:99], a[104:107], v[28:31]
    buffer_load_dwordx4 a[144:147], v23, s[36:39], s96 offen offset:3072 sc1
    v_mfma_f32_16x16x32_bf16 v[32:35], v[100:103], a[104:107], v[32:35]
    v_mfma_f32_16x16x32_bf16 v[36:39], v[104:107], a[104:107], v[36:39]
    ds_write_b128 v13, v[56:59] offset:4224
    v_mfma_f32_16x16x32_bf16 v[40:43], v[108:111], a[104:107], v[40:43]
    s_waitcnt vmcnt(9)
    v_mfma_f32_16x16x32_bf16 v[28:31], v[112:115], a[108:111], v[28:31]
    s_add_u32 s96, s3, 139264
    buffer_load_dwordx4 a[148:151], v23, s[36:39], s96 offen offset:0 sc1
    v_mfma_f32_16x16x32_bf16 v[32:35], v[116:119], a[108:111], v[32:35]
    v_mfma_f32_16x16x32_bf16 v[36:39], v[120:123], a[108:111], v[36:39]
    v_mfma_f32_16x16x32_bf16 v[40:43], v[124:127], a[108:111], v[40:43]
    s_waitcnt vmcnt(9)
    v_mfma_f32_16x16x32_bf16 v[28:31], v[128:131], a[112:115], v[28:31]
    buffer_load_dwordx4 a[152:155], v23, s[36:39], s96 offen offset:1024 sc1
    v_mfma_f32_16x16x32_bf16 v[32:35], v[132:135], a[112:115], v[32:35]
    v_mfma_f32_16x16x32_bf16 v[36:39], v[136:139], a[112:115], v[36:39]
    v_mfma_f32_16x16x32_bf16 v[40:43], v[140:143], a[112:115], v[40:43]
    s_waitcnt lgkmcnt(0)
    s_barrier
    ds_read_b128 v[60:63], v235 offset:0
    ds_read_b128 v[64:67], v15 offset:0
    ds_read_b128 v[68:71], v235 offset:8192
    ds_read_b128 v[72:75], v15 offset:8192
    ds_read_b128 v[76:79], v235 offset:16384
    ds_read_b128 v[80:83], v15 offset:16384
    ds_read_b128 v[84:87], v235 offset:24576
    ds_read_b128 v[88:91], v15 offset:24576
    s_waitcnt vmcnt(9)
    v_mfma_f32_16x16x32_bf16 v[28:31], v[144:147], a[116:119], v[28:31]
    buffer_load_dwordx4 a[156:159], v23, s[36:39], s96 offen offset:2048 sc1
    v_mfma_f32_16x16x32_bf16 v[32:35], v[148:151], a[116:119], v[32:35]
    v_mfma_f32_16x16x32_bf16 v[36:39], v[152:155], a[116:119], v[36:39]
    v_mfma_f32_16x16x32_bf16 v[40:43], v[156:159], a[116:119], v[40:43]
    s_waitcnt vmcnt(9)
    v_mfma_f32_16x16x32_bf16 v[28:31], v[160:163], a[120:123], v[28:31]
    buffer_load_dwordx4 a[160:163], v23, s[36:39], s96 offen offset:3072 sc1
    v_mfma_f32_16x16x32_bf16 v[32:35], v[164:167], a[120:123], v[32:35]
    v_mfma_f32_16x16x32_bf16 v[36:39], v[168:171], a[120:123], v[36:39]
    v_mfma_f32_16x16x32_bf16 v[40:43], v[172:175], a[120:123], v[40:43]
    s_waitcnt vmcnt(9)
    v_mfma_f32_16x16x32_bf16 v[28:31], v[176:179], a[124:127], v[28:31]
    s_add_u32 s96, s3, 143360
    buffer_load_dwordx4 a[164:167], v23, s[36:39], s96 offen offset:0 sc1
    v_mfma_f32_16x16x32_bf16 v[32:35], v[180:183], a[124:127], v[32:35]
    v_lshlrev_b32 v224, 16, v240
    v_and_b32 v225, 0xffff0000, v240
    v_mfma_f32_16x16x32_bf16 v[36:39], v[184:187], a[124:127], v[36:39]
    v_lshlrev_b32 v226, 16, v241
    v_and_b32 v227, 0xffff0000, v241
    v_mfma_f32_16x16x32_bf16 v[40:43], v[188:191], a[124:127], v[40:43]
    s_waitcnt vmcnt(9)
    v_mfma_f32_16x16x32_bf16 v[28:31], v[192:195], a[128:131], v[28:31]
    buffer_load_dwordx4 a[168:171], v23, s[36:39], s96 offen offset:1024 sc1
    v_mfma_f32_16x16x32_bf16 v[32:35], v[196:199], a[128:131], v[32:35]
    v_lshlrev_b32 v228, 16, v242
    v_and_b32 v229, 0xffff0000, v242
    v_mfma_f32_16x16x32_bf16 v[36:39], v[200:203], a[128:131], v[36:39]
    v_lshlrev_b32 v230, 16, v243
    v_and_b32 v231, 0xffff0000, v243
    v_mfma_f32_16x16x32_bf16 v[40:43], v[204:207], a[128:131], v[40:43]
    s_waitcnt vmcnt(9)
    v_mfma_f32_16x16x32_bf16 v[44:47], a[192:195], a[132:135], 0
    buffer_load_dwordx4 a[172:175], v11, s[36:39], s96 offen offset:2048 sc1
    v_mfma_f32_16x16x32_bf16 v[48:51], a[196:199], a[132:135], 0
    s_waitcnt lgkmcnt(0)
    v_add_f32 v60, v60, v68
    v_add_f32 v61, v61, v69
    v_mfma_f32_16x16x32_bf16 v[52:55], a[200:203], a[132:135], 0
    v_add_f32 v62, v62, v70
    v_add_f32 v63, v63, v71
    v_mfma_f32_16x16x32_bf16 v[56:59], a[204:207], a[132:135], 0
    s_waitcnt vmcnt(9)
    v_mfma_f32_16x16x32_bf16 v[44:47], a[208:211], a[136:139], v[44:47]
    v_mfma_f32_16x16x32_bf16 v[48:51], a[212:215], a[136:139], v[48:51]
    v_add_f32 v64, v64, v72
    v_add_f32 v65, v65, v73
    v_mfma_f32_16x16x32_bf16 v[52:55], a[216:219], a[136:139], v[52:55]
    ds_write_b128 v12, v[28:31] offset:32768
    v_add_f32 v66, v66, v74
    v_add_f32 v67, v67, v75
    v_mfma_f32_16x16x32_bf16 v[56:59], a[220:223], a[136:139], v[56:59]
    s_waitcnt vmcnt(8)
    v_mfma_f32_16x16x32_bf16 v[44:47], a[224:227], a[140:143], v[44:47]
    v_mfma_f32_16x16x32_bf16 v[48:51], a[228:231], a[140:143], v[48:51]
    v_add_f32 v76, v76, v84
    v_add_f32 v77, v77, v85
    v_mfma_f32_16x16x32_bf16 v[52:55], a[232:235], a[140:143], v[52:55]
    ds_write_b128 v13, v[32:35] offset:32768
    v_add_f32 v78, v78, v86
    v_add_f32 v79, v79, v87
    v_mfma_f32_16x16x32_bf16 v[56:59], a[236:239], a[140:143], v[56:59]
    s_waitcnt vmcnt(7)
    v_mfma_f32_16x16x32_bf16 v[44:47], a[240:243], a[144:147], v[44:47]
    v_mfma_f32_16x16x32_bf16 v[48:51], a[244:247], a[144:147], v[48:51]
    v_add_f32 v80, v80, v88
    v_add_f32 v81, v81, v89
    v_mfma_f32_16x16x32_bf16 v[52:55], a[248:251], a[144:147], v[52:55]
    ds_write_b128 v12, v[36:39] offset:32896
    v_add_f32 v82, v82, v90
    v_add_f32 v83, v83, v91
    v_mfma_f32_16x16x32_bf16 v[56:59], a[252:255], a[144:147], v[56:59]
    s_waitcnt vmcnt(6)
    v_mfma_f32_16x16x32_bf16 v[44:47], v[96:99], a[148:151], v[44:47]
    v_mfma_f32_16x16x32_bf16 v[48:51], v[100:103], a[148:151], v[48:51]
    v_add_f32 v60, v60, v76
    v_add_f32 v61, v61, v77
    v_mfma_f32_16x16x32_bf16 v[52:55], v[104:107], a[148:151], v[52:55]
    ds_write_b128 v13, v[40:43] offset:32896
    v_add_f32 v62, v62, v78
    v_add_f32 v63, v63, v79
    v_mfma_f32_16x16x32_bf16 v[56:59], v[108:111], a[148:151], v[56:59]
    s_waitcnt vmcnt(5)
    v_mfma_f32_16x16x32_bf16 v[44:47], v[112:115], a[152:155], v[44:47]
    v_mfma_f32_16x16x32_bf16 v[48:51], v[116:119], a[152:155], v[48:51]
    v_add_f32 v64, v64, v80
    v_add_f32 v65, v65, v81
    v_mfma_f32_16x16x32_bf16 v[52:55], v[120:123], a[152:155], v[52:55]
    v_add_f32 v66, v66, v82
    v_add_f32 v67, v67, v83
    v_mfma_f32_16x16x32_bf16 v[56:59], v[124:127], a[152:155], v[56:59]
    s_waitcnt vmcnt(4)
    v_mfma_f32_16x16x32_bf16 v[44:47], v[128:131], a[156:159], v[44:47]
    v_mfma_f32_16x16x32_bf16 v[48:51], v[132:135], a[156:159], v[48:51]
    v_add_f32 v60, v60, v224
    v_add_f32 v61, v61, v225
    v_mfma_f32_16x16x32_bf16 v[52:55], v[136:139], a[156:159], v[52:55]
    v_add_f32 v62, v62, v226
    v_add_f32 v63, v63, v227
    v_mfma_f32_16x16x32_bf16 v[56:59], v[140:143], a[156:159], v[56:59]
    s_waitcnt vmcnt(3)
    v_mfma_f32_16x16x32_bf16 v[44:47], v[144:147], a[160:163], v[44:47]
    v_mfma_f32_16x16x32_bf16 v[48:51], v[148:151], a[160:163], v[48:51]
    v_add_f32 v64, v64, v228
    v_add_f32 v65, v65, v229
    v_mfma_f32_16x16x32_bf16 v[52:55], v[152:155], a[160:163], v[52:55]
    v_add_f32 v66, v66, v230
    v_add_f32 v67, v67, v231
    v_mfma_f32_16x16x32_bf16 v[56:59], v[156:159], a[160:163], v[56:59]
    s_waitcnt vmcnt(2)
    v_mfma_f32_16x16x32_bf16 v[44:47], v[160:163], a[164:167], v[44:47]
    v_mfma_f32_16x16x32_bf16 v[48:51], v[164:167], a[164:167], v[48:51]
    v_cvt_pk_bf16_f32 v240, v60, v61
    v_cvt_pk_bf16_f32 v241, v62, v63
    v_mfma_f32_16x16x32_bf16 v[52:55], v[168:171], a[164:167], v[52:55]
    v_cvt_pk_bf16_f32 v242, v64, v65
    v_cvt_pk_bf16_f32 v243, v66, v67
    v_mfma_f32_16x16x32_bf16 v[56:59], v[172:175], a[164:167], v[56:59]
    s_waitcnt vmcnt(1)
    v_mfma_f32_16x16x32_bf16 v[44:47], v[176:179], a[168:171], v[44:47]
    v_mfma_f32_16x16x32_bf16 v[48:51], v[180:183], a[168:171], v[48:51]
    buffer_store_dwordx4 v[240:243], v223, s[32:35], 0 offen sc1
    v_mfma_f32_16x16x32_bf16 v[52:55], v[184:187], a[168:171], v[52:55]
    v_mfma_f32_16x16x32_bf16 v[56:59], v[188:191], a[168:171], v[56:59]
    s_waitcnt vmcnt(1)
    v_mfma_f32_16x16x32_bf16 v[44:47], v[192:195], a[172:175], v[44:47]
    v_mfma_f32_16x16x32_bf16 v[48:51], v[196:199], a[172:175], v[48:51]
    v_mfma_f32_16x16x32_bf16 v[52:55], v[200:203], a[172:175], v[52:55]
    v_mfma_f32_16x16x32_bf16 v[56:59], v[204:207], a[172:175], v[56:59]
    s_nop 4
    ds_write_b128 v12, v[44:47] offset:36864
    ds_write_b128 v13, v[48:51] offset:36864
    ds_write_b128 v12, v[52:55] offset:36992
    ds_write_b128 v13, v[56:59] offset:36992
    s_waitcnt lgkmcnt(0)
    s_barrier
    ds_read_b128 v[60:63], v235 offset:32768
    ds_read_b128 v[64:67], v15 offset:32768
    ds_read_b128 v[68:71], v235 offset:40960
    ds_read_b128 v[72:75], v15 offset:40960
    ds_read_b128 v[76:79], v235 offset:49152
    ds_read_b128 v[80:83], v15 offset:49152
    ds_read_b128 v[84:87], v235 offset:57344
    ds_read_b128 v[88:91], v15 offset:57344
    v_lshlrev_b32 v224, 16, v244
    v_and_b32 v225, 0xffff0000, v244
    v_lshlrev_b32 v226, 16, v245
    v_and_b32 v227, 0xffff0000, v245
    v_lshlrev_b32 v228, 16, v246
    v_and_b32 v229, 0xffff0000, v246
    v_lshlrev_b32 v230, 16, v247
    v_and_b32 v231, 0xffff0000, v247
    s_waitcnt lgkmcnt(5)
    v_pk_add_f32 v[60:61], v[60:61], v[68:69]
    v_pk_add_f32 v[62:63], v[62:63], v[70:71]
    s_waitcnt lgkmcnt(4)
    v_pk_add_f32 v[64:65], v[64:65], v[72:73]
    v_pk_add_f32 v[66:67], v[66:67], v[74:75]
    s_waitcnt lgkmcnt(1)
    v_pk_add_f32 v[76:77], v[76:77], v[84:85]
    v_pk_add_f32 v[78:79], v[78:79], v[86:87]
    s_waitcnt lgkmcnt(0)
    v_pk_add_f32 v[80:81], v[80:81], v[88:89]
    v_pk_add_f32 v[82:83], v[82:83], v[90:91]
    v_pk_add_f32 v[60:61], v[60:61], v[76:77]
    v_pk_add_f32 v[62:63], v[62:63], v[78:79]
    v_pk_add_f32 v[64:65], v[64:65], v[80:81]
    v_pk_add_f32 v[66:67], v[66:67], v[82:83]
    v_pk_add_f32 v[60:61], v[60:61], v[224:225]
    v_pk_add_f32 v[62:63], v[62:63], v[226:227]
    v_pk_add_f32 v[64:65], v[64:65], v[228:229]
    v_pk_add_f32 v[66:67], v[66:67], v[230:231]
    v_cvt_pk_bf16_f32 v244, v60, v61
    v_cvt_pk_bf16_f32 v245, v62, v63
    v_cvt_pk_bf16_f32 v246, v64, v65
    v_cvt_pk_bf16_f32 v247, v66, v67
    buffer_store_dwordx4 v[244:247], v223, s[32:35], s54 offen sc1
L_end:
    s_endpgm
L_cold11:
    s_mov_b32 s61, 0
L_cold11_l:
    s_sleep 2
    buffer_load_dwordx4 v[28:31], v18, s[36:39], s8 offen offset:0 sc1
    buffer_load_dwordx3 v[32:34], v19, s[36:39], s8 offen offset:0 sc1
    buffer_load_dwordx4 v[36:39], v18, s[36:39], s8 offen offset:1152 sc1
    buffer_load_dwordx3 v[40:42], v19, s[36:39], s8 offen offset:1152 sc1
    buffer_load_dwordx4 v[44:47], v18, s[36:39], s8 offen offset:2304 sc1
    buffer_load_dwordx3 v[48:50], v19, s[36:39], s8 offen offset:2304 sc1
    buffer_load_dwordx4 v[52:55], v18, s[36:39], s9 offen offset:0 sc1
    buffer_load_dwordx3 v[56:58], v19, s[36:39], s9 offen offset:0 sc1
    s_add_u32 s61, s61, 1
    s_cmp_gt_u32 s61, 400000
    s_waitcnt vmcnt(0)
    v_bitop3_b32 v9, v29, v34, s49 bitop3:0x7e
    v_cmp_ne_u32 vcc, 0, v9
    s_cbranch_scc1 L_cold11_r
    s_nop 0
    s_cbranch_vccnz L_cold11_l
    s_branch L_cold11_r
L_cold12:
    s_mov_b32 s61, 0
L_cold12_l:
    s_sleep 2
    buffer_load_dwordx4 v[36:39], v18, s[36:39], s8 offen offset:1152 sc1
    buffer_load_dwordx3 v[40:42], v19, s[36:39], s8 offen offset:1152 sc1
    buffer_load_dwordx4 v[44:47], v18, s[36:39], s8 offen offset:2304 sc1
    buffer_load_dwordx3 v[48:50], v19, s[36:39], s8 offen offset:2304 sc1
    buffer_load_dwordx4 v[52:55], v18, s[36:39], s9 offen offset:0 sc1
    buffer_load_dwordx3 v[56:58], v19, s[36:39], s9 offen offset:0 sc1
    buffer_load_dwordx4 v[60:63], v18, s[36:39], s9 offen offset:1152 sc1
    buffer_load_dwordx3 v[64:66], v19, s[36:39], s9 offen offset:1152 sc1
    s_add_u32 s61, s61, 1
    s_cmp_gt_u32 s61, 400000
    s_waitcnt vmcnt(0)
    v_bitop3_b32 v9, v37, v42, s49 bitop3:0x7e
    v_cmp_ne_u32 vcc, 0, v9
    s_cbranch_scc1 L_cold12_r
    s_nop 0
    s_cbranch_vccnz L_cold12_l
    s_branch L_cold12_r
L_cold13:
    s_mov_b32 s61, 0
L_cold13_l:
    s_sleep 2
    buffer_load_dwordx4 v[44:47], v18, s[36:39], s8 offen offset:2304 sc1
    buffer_load_dwordx3 v[48:50], v19, s[36:39], s8 offen offset:2304 sc1
    buffer_load_dwordx4 v[52:55], v18, s[36:39], s9 offen offset:0 sc1
    buffer_load_dwordx3 v[56:58], v19, s[36:39], s9 offen offset:0 sc1
    buffer_load_dwordx4 v[60:63], v18, s[36:39], s9 offen offset:1152 sc1
    buffer_load_dwordx3 v[64:66], v19, s[36:39], s9 offen offset:1152 sc1
    buffer_load_dwordx4 v[68:71], v18, s[36:39], s9 offen offset:2304 sc1
    buffer_load_dwordx3 v[72:74], v19, s[36:39], s9 offen offset:2304 sc1
    s_add_u32 s61, s61, 1
    s_cmp_gt_u32 s61, 400000
    s_waitcnt vmcnt(0)
    v_bitop3_b32 v9, v45, v50, s49 bitop3:0x7e
    v_cmp_ne_u32 vcc, 0, v9
    s_cbranch_scc1 L_cold13_r
    s_nop 0
    s_cbranch_vccnz L_cold13_l
    s_branch L_cold13_r
L_cold14:
    s_mov_b32 s61, 0
L_cold14_l:
    s_sleep 2
    buffer_load_dwordx4 v[52:55], v18, s[36:39], s9 offen offset:0 sc1
    buffer_load_dwordx3 v[56:58], v19, s[36:39], s9 offen offset:0 sc1
    buffer_load_dwordx4 v[60:63], v18, s[36:39], s9 offen offset:1152 sc1
    buffer_load_dwordx3 v[64:66], v19, s[36:39], s9 offen offset:1152 sc1
    buffer_load_dwordx4 v[68:71], v18, s[36:39], s9 offen offset:2304 sc1
    buffer_load_dwordx3 v[72:74], v19, s[36:39], s9 offen offset:2304 sc1
    buffer_load_dwordx4 v[76:79], v18, s[36:39], s10 offen offset:0 sc1
    buffer_load_dwordx3 v[80:82], v19, s[36:39], s10 offen offset:0 sc1
    s_add_u32 s61, s61, 1
    s_cmp_gt_u32 s61, 400000
    s_waitcnt vmcnt(0)
    v_bitop3_b32 v9, v53, v58, s49 bitop3:0x7e
    v_cmp_ne_u32 vcc, 0, v9
    s_cbranch_scc1 L_cold14_r
    s_nop 0
    s_cbranch_vccnz L_cold14_l
    s_branch L_cold14_r
L_cold15:
    s_mov_b32 s61, 0
L_cold15_l:
    s_sleep 2
    buffer_load_dwordx4 v[60:63], v18, s[36:39], s9 offen offset:1152 sc1
    buffer_load_dwordx3 v[64:66], v19, s[36:39], s9 offen offset:1152 sc1
    buffer_load_dwordx4 v[68:71], v18, s[36:39], s9 offen offset:2304 sc1
    buffer_load_dwordx3 v[72:74], v19, s[36:39], s9 offen offset:2304 sc1
    buffer_load_dwordx4 v[76:79], v18, s[36:39], s10 offen offset:0 sc1
    buffer_load_dwordx3 v[80:82], v19, s[36:39], s10 offen offset:0 sc1
    buffer_load_dwordx4 v[84:87], v18, s[36:39], s10 offen offset:1152 sc1
    buffer_load_dwordx3 v[88:90], v19, s[36:39], s10 offen offset:1152 sc1
    s_add_u32 s61, s61, 1
    s_cmp_gt_u32 s61, 400000
    s_waitcnt vmcnt(0)
    v_bitop3_b32 v9, v61, v66, s49 bitop3:0x7e
    v_cmp_ne_u32 vcc, 0, v9
    s_cbranch_scc1 L_cold15_r
    s_nop 0
    s_cbranch_vccnz L_cold15_l
    s_branch L_cold15_r
L_cold16:
    s_mov_b32 s61, 0
L_cold16_l:
    s_sleep 2
    buffer_load_dwordx4 v[68:71], v18, s[36:39], s9 offen offset:2304 sc1
    buffer_load_dwordx3 v[72:74], v19, s[36:39], s9 offen offset:2304 sc1
    buffer_load_dwordx4 v[76:79], v18, s[36:39], s10 offen offset:0 sc1
    buffer_load_dwordx3 v[80:82], v19, s[36:39], s10 offen offset:0 sc1
    buffer_load_dwordx4 v[84:87], v18, s[36:39], s10 offen offset:1152 sc1
    buffer_load_dwordx3 v[88:90], v19, s[36:39], s10 offen offset:1152 sc1
    s_add_u32 s61, s61, 1
    s_cmp_gt_u32 s61, 400000
    s_waitcnt vmcnt(0)
    v_bitop3_b32 v9, v69, v74, s49 bitop3:0x7e
    v_cmp_ne_u32 vcc, 0, v9
    s_cbranch_scc1 L_cold16_r
    s_nop 0
    s_cbranch_vccnz L_cold16_l
    s_branch L_cold16_r
L_cold17:
    s_mov_b32 s61, 0
L_cold17_l:
    s_sleep 2
    buffer_load_dwordx4 v[76:79], v18, s[36:39], s10 offen offset:0 sc1
    buffer_load_dwordx3 v[80:82], v19, s[36:39], s10 offen offset:0 sc1
    buffer_load_dwordx4 v[84:87], v18, s[36:39], s10 offen offset:1152 sc1
    buffer_load_dwordx3 v[88:90], v19, s[36:39], s10 offen offset:1152 sc1
    s_add_u32 s61, s61, 1
    s_cmp_gt_u32 s61, 400000
    s_waitcnt vmcnt(0)
    v_bitop3_b32 v9, v77, v82, s49 bitop3:0x7e
    v_cmp_ne_u32 vcc, 0, v9
    s_cbranch_scc1 L_cold17_r
    s_nop 0
    s_cbranch_vccnz L_cold17_l
    s_branch L_cold17_r
L_cold18:
    s_mov_b32 s61, 0
L_cold18_l:
    s_sleep 2
    buffer_load_dwordx4 v[84:87], v18, s[36:39], s10 offen offset:1152 sc1
    buffer_load_dwordx3 v[88:90], v19, s[36:39], s10 offen offset:1152 sc1
    s_add_u32 s61, s61, 1
    s_cmp_gt_u32 s61, 400000
    s_waitcnt vmcnt(0)
    v_bitop3_b32 v9, v85, v90, s49 bitop3:0x7e
    v_cmp_ne_u32 vcc, 0, v9
    s_cbranch_scc1 L_cold18_r
    s_nop 0
    s_cbranch_vccnz L_cold18_l
    s_branch L_cold18_r
L_cold21:
    s_mov_b32 s61, 0
L_sp22:
    s_mov_b32 s62, 0
    s_atomic_or s62, s[36:37], s18 glc
    s_add_u32 s61, s61, 1
    s_cmp_gt_u32 s61, 400000
    s_waitcnt lgkmcnt(0)
    s_cbranch_scc1 L_spe23
L_sp22_t:
    s_sub_u32 s62, s62, 16
    s_branch L_pgo7
L_pg7:
    s_branch L_pgback5
L_pgo7:
    s_cmp_lg_u32 s62, s49
    s_cbranch_scc1 L_sp22
L_spe23:
    s_branch L_cold21_r
L_cold24:
    s_mov_b32 s61, 0
L_sp25:
    s_mov_b32 s62, 0
    s_atomic_or s62, s[36:37], s19 glc
    s_add_u32 s61, s61, 1
    s_cmp_gt_u32 s61, 400000
    s_waitcnt lgkmcnt(0)
    s_cbranch_scc1 L_spe26
L_sp25_t:
    s_sub_u32 s62, s62, 32
    s_cmp_lg_u32 s62, s49
    s_cbranch_scc1 L_sp25
L_spe26:
    s_branch L_cold24_r
L_cold27:
    s_mov_b32 s61, 0
L_sp28:
    s_mov_b32 s62, 0
    s_atomic_or s62, s[36:37], s18 glc
    s_add_u32 s61, s61, 1
    s_cmp_gt_u32 s61, 400000
    s_waitcnt lgkmcnt(0)
    s_cbranch_scc1 L_spe29
L_sp28_t:
    s_sub_u32 s62, s62, 16
    s_cmp_lg_u32 s62, s49
    s_cbranch_scc1 L_sp28
L_spe29:
    s_branch L_cold27_r
L_cold30:
    s_mov_b32 s61, 0
L_sp31:
    s_mov_b32 s62, 0
    s_atomic_or s62, s[36:37], s8 glc
    s_add_u32 s61, s61, 1
    s_cmp_gt_u32 s61, 400000
    s_waitcnt lgkmcnt(0)
    s_cbranch_scc1 L_spe32
L_sp31_t:
    s_sub_u32 s62, s62, 16
    s_cmp_lg_u32 s62, s49
    s_cbranch_scc1 L_sp31
L_spe32:
    s_branch L_cold30_r
L_cold35:
    s_mov_b32 s61, 0
L_sp36:
    s_mov_b32 s62, 0
    s_atomic_or s62, s[36:37], s18 glc
    s_add_u32 s61, s61, 1
    s_cmp_gt_u32 s61, 400000
    s_waitcnt lgkmcnt(0)
    s_cbranch_scc1 L_spe37
L_sp36_t:
    s_sub_u32 s62, s62, 16
    s_cmp_lg_u32 s62, s49
    s_cbranch_scc1 L_sp36
L_spe37:
    s_branch L_cold35_r
L_cold39:
    s_mov_b32 s61, 0
L_sp40:
    s_mov_b32 s62, 0
    s_atomic_or s62, s[36:37], s19 glc
    s_add_u32 s61, s61, 1
    s_cmp_gt_u32 s61, 400000
    s_waitcnt lgkmcnt(0)
    s_cbranch_scc1 L_spe41
L_sp40_t:
    s_sub_u32 s62, s62, 16
    s_cmp_lg_u32 s62, s49
    s_cbranch_scc1 L_sp40
L_spe41:
    s_branch L_cold39_r
L_pg8:
    s_branch L_pgback5
.fill (0xa800 - (. - sequential_preLN__linear_attn_block__swiglu_ffn__prompt_kernel)) / 4, 4, 0xbf800000
.section .rodata,"a"
.p2align 6
.amdhsa_kernel sequential_preLN__linear_attn_block__swiglu_ffn__prompt_kernel
  .amdhsa_next_free_vgpr 512
  .amdhsa_next_free_sgpr 102
  .amdhsa_accum_offset 256
  .amdhsa_group_segment_fixed_size 0
  .amdhsa_kernarg_size 80
  .amdhsa_user_sgpr_count 2
  .amdhsa_user_sgpr_kernarg_segment_ptr 1
  .amdhsa_system_sgpr_workgroup_id_x 1
  .amdhsa_float_denorm_mode_32 3
.end_amdhsa_kernel
```
